```python
import torch

def _softmax(x, axis=-1):
    return torch.softmax(x, dim=axis)
def _gelu(x):
    return torch.nn.functional.gelu(x, approximate="tanh")
def _silu(x):
    return torch.nn.functional.silu(x)
def _sigmoid(x):
    return torch.sigmoid(x)
def _layernorm(x, axis=-1, eps=1e-5):
    m = x.mean(dim=axis, keepdim=True)
    v = x.var(dim=axis, keepdim=True, unbiased=False)
    return (x - m) / torch.sqrt(v + eps)
def _scatter_add(tgt, idx, src, axis=0):
    return tgt.clone().index_add_(axis, idx, src)
def _segment_sum(src, seg, n):
    out = torch.zeros((n,) + src.shape[1:], dtype=src.dtype)
    return out.index_add_(0, seg, src)
def _pad(x, pw):
    flat = tuple(v for pair in reversed(pw) for v in pair)
    return torch.nn.functional.pad(x, flat)

kernel_name = 'recurrent_scan__sliding_local_dilated__dense_activation_gelu__prompt'

def setup_inputs():

    _w = (lambda a: (lambda t: t.to(torch.bfloat16) if t.is_floating_point() else t)(torch.as_tensor(a)))
    def _A_setup():
        B, S, D = 1, 2048, 640
        return {
            "x": _w((lambda *s: torch.randn(*s, dtype=torch.bfloat16) * 0.05)(B, S, D)),
            "wqkv": _w((lambda *s: torch.randn(*s, dtype=torch.bfloat16) * 0.2)(D, 3 * D)),
            "wo": _w((lambda *s: torch.randn(*s, dtype=torch.bfloat16) * 0.2)(D, D)),
        }
    _A_in = _A_setup()

    def _B_setup():
        B, S, D, F = 1, 2048, 640, 1728
        return {
            "x": _w((lambda *s: torch.randn(*s, dtype=torch.bfloat16) * 0.05)(B, S, D)),
            "w1": _w((lambda *s: torch.randn(*s, dtype=torch.bfloat16) * 1.6)(D, F) * (D ** -0.5)),
            "b1": _w((lambda *s: torch.randn(*s, dtype=torch.bfloat16) * 1.6)(F) * 0.01),
            "w2": _w((lambda *s: torch.randn(*s, dtype=torch.bfloat16) * 0.1)(F, D) * (F ** -0.5)),
            "b2": _w((lambda *s: torch.randn(*s, dtype=torch.bfloat16) * 0.1)(D) * 0.01),
        }
    _B_in = _B_setup()

    return {
        "A_x": _A_in["x"],
        "A_wqkv": _A_in["wqkv"],
        "A_wo": _A_in["wo"],
        "B_x": _B_in["x"],
        "B_w1": _B_in["w1"],
        "B_b1": _B_in["b1"],
        "B_w2": _B_in["w2"],
        "B_b2": _B_in["b2"],
    }

def reference(A_x, A_wqkv, A_wo, B_x, B_w1, B_b1, B_w2, B_b2):
    def _A_ref(x, wqkv, wo):
        B, S, D = x.shape
        H = 32; Dh = D // H
        W, dil = 8, 2
        qkv = (lambda x, *d: x.permute(*d))((x @ wqkv).reshape(B, S, 3, H, Dh), 2, 0, 3, 1, 4)
        q, k, v = qkv[0], qkv[1], qkv[2]
        scale = Dh ** -0.5
        pos = torch.arange(S)
        off = torch.arange(W) * dil
        idx = pos[:, None] - off[None, :]
        mask = idx >= 0
        idx_c = torch.where(mask, idx, 0).reshape(-1)
        kg = k[:, :, idx_c, :].reshape(B, H, S, W, Dh)
        vg = v[:, :, idx_c, :].reshape(B, H, S, W, Dh)
        logits = torch.einsum("bhsd,bhswd->bhsw", q, kg) * scale
        logits = torch.where(mask[None, None, :, :], logits, -1e9)
        attn = _softmax(logits, axis=-1)
        o = torch.einsum("bhsw,bhswd->bhsd", attn, vg)
        return (lambda x, *d: x.permute(*d))(o, 0, 2, 1, 3).reshape(B, S, D) @ wo

    def _B_ref(x, w1, b1, w2, b2):
        h = torch.einsum("bsd,df->bsf", x, w1) + b1
        h = _gelu(h)
        return torch.einsum("bsf,fd->bsd", h, w2) + b2

    x = A_x
    xn = _layernorm(x, axis=-1)
    s = _A_ref(xn, A_wqkv, A_wo)
    g = _silu(_B_ref(xn, B_w1, B_b1, B_w2, B_b2))
    return x + s * g
```

```asm
; @launch grid=(256,1,1) block=(512,1,1) lds=163840
.amdgcn_target "amdgcn-amd-amdhsa--gfx950"
.text
.globl recurrent_scan__sliding_local_dilated__dense_activation_gelu__prompt_kernel
.p2align 8
.type recurrent_scan__sliding_local_dilated__dense_activation_gelu__prompt_kernel,@function
recurrent_scan__sliding_local_dilated__dense_activation_gelu__prompt_kernel:
    s_cmp_ge_u32 s2, 256
    s_cbranch_scc1 Lend
    s_load_dwordx16 s[40:55], s[0:1], 0
    s_load_dwordx4 s[56:59], s[0:1], 64
    s_load_dwordx2 s[60:61], s[0:1], 80
    v_lshrrev_b32 v4, 6, v0
    v_and_b32 v1, 63, v0
    v_readfirstlane_b32 s62, v4
    v_lshrrev_b32 v2, 4, v1
    v_and_b32 v3, 15, v1
    v_lshlrev_b32 v9, 4, v1
    s_lshl_b32 s72, s62, 11
    s_mov_b32 s65, 0
    s_bfe_u32 s75, s2, 0x40003
    s_lshr_b32 s76, s2, 7
    s_and_b32 s73, s2, 1
    s_bfe_u32 s74, s2, 0x20001
    s_mov_b32 s87, 0
    v_mov_b32 v254, 0
    s_cmp_ge_u32 s62, 3
    s_cbranch_scc1 Lpf_4
    s_cmp_ge_u32 s62, 1
    s_cbranch_scc1 Lpf_2
    s_lshl_b32 s73, s73, 10
    s_lshl_b32 s74, s74, 8
    s_lshl_b32 s75, s75, 4
    s_add_u32 s73, s73, s74
    s_add_u32 s73, s73, s75
    v_add_u32 v4, s73, v3
    v_mul_u32_u24 v4, 1280, v4
    v_and_b32 v5, 1, v2
    v_lshl_add_u32 v254, v5, 7, v4
    s_lshl_b32 s73, s76, 8
    s_mov_b32 s86, 256
    s_mov_b32 s87, 1280
    s_waitcnt lgkmcnt(0)
    s_mov_b32 s46, 512
    s_mov_b32 s36, s40
    s_mov_b32 s37, s41
    s_mov_b32 s38, 2621440
    s_mov_b32 s39, 0x00020000
    buffer_load_dword v255, v254, s[36:39], s73 offen
    s_branch Lpf_3
Lpf_2:
    s_cmp_eq_u32 s62, 2
    s_cbranch_scc1 Lpf_1
    v_min_u32 v4, 35, v1
    v_mul_u32_u24 v5, 57, v4
    v_lshrrev_b32 v5, 9, v5
    v_mul_u32_u24 v7, 9, v5
    v_sub_u32 v4, v4, v7
    s_lshl_b32 s75, s75, 2
    v_add_u32 v5, s75, v5
    v_mul_u32_u24 v5, 3840, v5
    v_mul_u32_u24 v7, 43, v4
    v_lshrrev_b32 v7, 7, v7
    v_mul_u32_u24 v7, 896, v7
    v_lshl_add_u32 v4, v4, 7, v7
    s_mul_i32 s74, s74, 320
    s_and_b32 s74, s74, 0xffffff80
    v_add3_u32 v254, v4, v5, s74
    s_mul_i32 s73, s76, 491520
    s_add_u32 s74, s73, 245760
    s_mov_b32 s86, 245760
    s_mov_b32 s87, 2457600
    s_waitcnt lgkmcnt(0)
    s_mov_b32 s46, 983040
    s_mov_b32 s36, s42
    s_mov_b32 s37, s43
    s_mov_b32 s38, 2457600
    s_mov_b32 s39, 0x00020000
    buffer_load_dword v255, v254, s[36:39], s73 offen
    buffer_load_dword v255, v254, s[36:39], s74 offen
    s_branch Lpf_3
Lpf_1:
    s_and_b32 s73, s2, 127
    s_mul_i32 s73, s73, 3456
    v_min_u32 v4, 26, v1
    v_lshl_add_u32 v254, v4, 7, s73
    s_mul_i32 s73, s76, 442368
    s_mov_b32 s86, 442368
    s_mov_b32 s87, 2211840
    s_waitcnt lgkmcnt(0)
    s_mov_b32 s46, 884736
    s_mov_b32 s36, s48
    s_mov_b32 s37, s49
    s_mov_b32 s38, 2211840
    s_mov_b32 s39, 0x00020000
    buffer_load_dword v255, v254, s[36:39], s73 offen
    s_branch Lpf_3
Lpf_4:
    s_cmp_lg_u32 s62, 7
    s_cbranch_scc1 Lcp_5
    s_getpc_b64 s[82:83]
    s_and_b32 s82, s82, 0xffffff00
    s_lshr_b32 s73, s2, 3
    s_mul_i32 s73, s73, 10
    v_min_u32 v4, 9, v1
    v_add_u32 v4, s73, v4
    v_lshlrev_b32 v4, 7, v4
    v_min_u32 v4, Lend-Lcp_5, v4
    global_load_dword v255, v4, s[82:83]
Lcp_5:
    s_cmp_lg_u32 s2, 0
    s_cbranch_scc1 Ln_6
    s_cmp_lg_u32 s62, 7
    s_cbranch_scc1 Ln_6
    s_waitcnt lgkmcnt(0)
    s_mov_b32 s32, s58
    s_mov_b32 s33, s59
    s_mov_b32 s34, 256
    s_mov_b32 s35, 0x00020000
    s_memrealtime s[82:83]
    s_waitcnt lgkmcnt(0)
    s_or_b32 s82, s82, 1
    v_mov_b32 v4, s82
    v_mov_b32 v5, s83
    v_mov_b32 v6, 0
    s_mov_b64 exec, 1
    buffer_store_dwordx2 v[4:5], v6, s[32:35], 0 offen sc1
    s_mov_b64 exec, -1
Ln_6:
    s_waitcnt lgkmcnt(0)
    s_mov_b32 s36, s40
    s_mov_b32 s37, s41
    s_mov_b32 s38, 2621440
    s_mov_b32 s39, 0x00020000
    s_mov_b32 s86, 0
    s_mov_b32 s46, 0
Lpf_3:
    s_mov_b32 s4, s40
    s_mov_b32 s5, s41
    s_mov_b32 s6, 2621440
    s_mov_b32 s7, 0x00020000
    s_and_b32 s73, s2, 1
    s_bfe_u32 s74, s2, 0x20001
    s_lshr_b32 s75, s2, 3
    s_cmp_ge_u32 s75, 16
    s_cbranch_scc1 Lffn
    s_lshl_b32 s63, s73, 3
    s_and_b32 s76, s75, 7
    s_add_u32 s63, s63, s76
    s_lshl_b32 s64, s74, 1
    s_lshr_b32 s76, s75, 3
    s_add_u32 s64, s64, s76
    s_lshl_b32 s76, s63, 7
    s_sub_u32 s76, s76, 16
    s_mul_i32 s15, s64, 160
    s_cmp_eq_u32 s62, 1
    s_cselect_b32 s87, s87, 0
    s_mov_b32 s46, 1966080
    s_lshl_b32 s73, s62, 4
    s_add_u32 s73, s73, s76
    s_max_i32 s73, s73, 0
    s_mul_i32 s12, s73, 1280
    s_sub_u32 s12, s12, 128
    s_lshl_b32 s73, s62, 3
    s_add_u32 s73, s73, s76
    s_mul_i32 s13, s73, 1280
    s_add_u32 s13, s13, 163712
    s_lshl_b32 s14, s62, 10
    s_add_u32 s14, s14, 16384
    v_lshrrev_b32 v4, 3, v1
    v_mul_u32_u24 v4, 1280, v4
    v_xor_b32 v5, v2, v1
    v_and_b32 v5, 7, v5
    v_lshl_add_u32 v11, v5, 4, v4
    v_xor_b32 v6, 64, v11
    v_add_u32 v12, 9216, v6
    s_and_b32 s73, s62, 1
    s_lshl_b32 s74, s73, 6
    v_xor_b32 v124, s74, v11
    s_lshl_b32 s73, s73, 2
    s_lshr_b32 s74, s62, 1
    s_lshl_b32 s74, s74, 4
    s_add_u32 s73, s73, s74
    s_mul_i32 s67, s73, 3840
    s_add_u32 s67, s67, s15
    s_sub_u32 s67, s67, 245760
    s_mov_b32 s100, -1
    s_mov_b32 s101, 0xffff
    s_mul_i32 s47, s62, 3840
    s_add_u32 s47, s47, 18432
    v_add_u32 v4, 0, v1
    v_mul_u32_u24 v5, 2185, v4
    v_lshrrev_b32 v5, 16, v5
    v_mul_u32_u24 v6, 30, v5
    v_sub_u32 v4, v4, v6
    v_mul_u32_u24 v6, 26, v4
    v_lshrrev_b32 v6, 8, v6
    v_mul_u32_u24 v6, 1120, v6
    v_lshl_add_u32 v4, v4, 4, v6
    v_and_b32 v6, 4, v5
    v_add_u32 v5, v5, v6
    v_mul_u32_u24 v5, 3840, v5
    v_add_u32 v4, v4, v5
    v_subrev_u32 v120, 0, v4
    v_add_u32 v4, 64, v1
    v_mul_u32_u24 v5, 2185, v4
    v_lshrrev_b32 v5, 16, v5
    v_mul_u32_u24 v6, 30, v5
    v_sub_u32 v4, v4, v6
    v_mul_u32_u24 v6, 26, v4
    v_lshrrev_b32 v6, 8, v6
    v_mul_u32_u24 v6, 1120, v6
    v_lshl_add_u32 v4, v4, 4, v6
    v_and_b32 v6, 4, v5
    v_add_u32 v5, v5, v6
    v_mul_u32_u24 v5, 3840, v5
    v_add_u32 v4, v4, v5
    v_subrev_u32 v121, 1024, v4
    v_add_u32 v4, 128, v1
    v_mul_u32_u24 v5, 2185, v4
    v_lshrrev_b32 v5, 16, v5
    v_mul_u32_u24 v6, 30, v5
    v_sub_u32 v4, v4, v6
    v_mul_u32_u24 v6, 26, v4
    v_lshrrev_b32 v6, 8, v6
    v_mul_u32_u24 v6, 1120, v6
    v_lshl_add_u32 v4, v4, 4, v6
    v_and_b32 v6, 4, v5
    v_add_u32 v5, v5, v6
    v_mul_u32_u24 v5, 3840, v5
    v_add_u32 v4, v4, v5
    v_subrev_u32 v122, 2048, v4
    v_add_u32 v4, 192, v1
    v_mul_u32_u24 v5, 2185, v4
    v_lshrrev_b32 v5, 16, v5
    v_mul_u32_u24 v6, 30, v5
    v_sub_u32 v4, v4, v6
    v_mul_u32_u24 v6, 26, v4
    v_lshrrev_b32 v6, 8, v6
    v_mul_u32_u24 v6, 1120, v6
    v_lshl_add_u32 v4, v4, 4, v6
    v_and_b32 v6, 4, v5
    v_add_u32 v5, v5, v6
    v_mul_u32_u24 v5, 3840, v5
    v_add_u32 v4, v4, v5
    v_subrev_u32 v123, 3072, v4
    s_mov_b32 s8, s42
    s_mov_b32 s9, s43
    s_mov_b32 s10, 2457600
    s_mov_b32 s11, 0x00020000
    s_add_u32 s73, s63, 16
    s_lshl_b32 s73, s73, 7
    s_lshl_b32 s74, s64, 3
    s_add_u32 s43, s73, s74
    s_cmp_lt_u32 s62, 2
    s_cselect_b64 vcc, -1, 0
    s_mov_b32 s69, 49152
    s_add_u32 m0, s69, s72
    s_add_u32 s12, s12, 128
    buffer_load_dwordx4 v11, s[4:7], s12 offen lds
    buffer_load_dwordx4 v12, s[4:7], s12 offen offset:1024 lds
    s_cbranch_vccz Lsk_7
    s_add_u32 m0, s69, s14
    s_add_u32 s13, s13, 128
    buffer_load_dwordx4 v124, s[4:7], s13 offen lds
Lsk_7:
    s_add_u32 m0, s69, s47
    s_add_u32 s67, s67, 245760
    buffer_load_dwordx4 v120, s[8:11], s67 offen offset:0 lds
    buffer_load_dwordx4 v121, s[8:11], s67 offen offset:1024 lds
    buffer_load_dwordx4 v122, s[8:11], s67 offen offset:2048 lds
    s_mov_b64 exec, s[100:101]
    buffer_load_dwordx4 v123, s[8:11], s67 offen offset:3072 lds
    s_mov_b64 exec, -1
    s_mov_b32 s16, s60
    s_mov_b32 s17, s61
    s_mov_b32 s18, 9699328
    s_mov_b32 s19, 0x00020000
    s_add_u32 s28, s60, 11534336
    s_addc_u32 s29, s61, 0
    s_mov_b32 s30, 4587520
    s_mov_b32 s31, 0x00020000
    s_mov_b32 s32, s58
    s_mov_b32 s33, s59
    s_mov_b32 s34, 256
    s_mov_b32 s35, 0x00020000
    s_lshr_b32 s77, s62, 2
    s_and_b32 s73, s62, 3
    s_lshl_b32 s73, s73, 2
    s_lshl_b32 s74, s77, 1
    s_xor_b32 s75, s74, 0
    s_add_u32 s75, s75, s73
    s_min_u32 s78, s75, 14
    s_xor_b32 s75, s74, 1
    s_add_u32 s75, s75, s73
    s_min_u32 s79, s75, 14
    s_xor_b32 s75, s74, 2
    s_add_u32 s75, s75, s73
    s_min_u32 s80, s75, 14
    s_xor_b32 s75, s74, 3
    s_add_u32 s75, s75, s73
    s_min_u32 s81, s75, 14
    s_mov_b32 s84, 0xfffefffe
    s_mov_b32 s85, 0xfffefffe
    v_lshrrev_b32 v4, 1, v3
    v_xor_b32 v4, v4, v2
    v_lshlrev_b32 v4, 4, v4
    v_lshl_add_u32 v4, v3, 7, v4
    v_add_u32 v15, 49152, v4
    v_xor_b32 v16, 64, v15
    s_lshl_b32 s73, s77, 13
    s_add_u32 s73, s73, 2048
    v_add_u32 v13, s73, v15
    v_add_u32 v14, s73, v16
    v_bfe_u32 v4, v1, 2, 3
    v_lshrrev_b32 v5, 5, v1
    v_lshl_add_u32 v4, v5, 4, v4
    v_mul_u32_u24 v4, 480, v4
    v_and_b32 v5, 3, v1
    v_lshl_add_u32 v4, v5, 3, v4
    s_lshl_b32 s73, s78, 5
    s_add_u32 s73, s73, 67584
    v_add_u32 v17, s73, v4
    s_lshl_b32 s73, s79, 5
    s_add_u32 s73, s73, 67584
    v_add_u32 v18, s73, v4
    s_lshl_b32 s73, s80, 5
    s_add_u32 s73, s73, 67584
    v_add_u32 v19, s73, v4
    s_lshl_b32 s73, s81, 5
    s_add_u32 s73, s73, 67584
    v_add_u32 v20, s73, v4
    v_lshlrev_b32 v22, 5, v3
    s_lshl_b32 s73, s63, 7
    s_lshl_b32 s74, s77, 6
    s_add_u32 s74, s74, s73
    s_lshl_b32 s74, s74, 5
    s_add_u32 s48, s74, 4456448
    s_sub_u32 s73, s73, 16
    s_max_i32 s73, s73, 0
    s_lshl_b32 s73, s73, 5
    s_add_u32 s49, s73, 4456448
    v_mov_b32 v168, 0x3f803f80
    v_mov_b32 v169, 0x3f803f80
    v_mov_b32 v170, 0x3f803f80
    v_mov_b32 v171, 0x3f803f80
    v_mov_b32 v172, 0x3f803f80
    v_mov_b32 v173, 0x3f803f80
    v_mov_b32 v174, 0x3f803f80
    v_mov_b32 v175, 0x3f803f80
    s_and_b32 s73, s2, 7
    s_lshl_b32 s50, s73, 2
    s_bfe_u32 s74, s2, 0x20003
    s_add_u32 s50, s50, s74
    s_lshr_b32 s51, s2, 5
    s_lshl_b32 s74, s74, 1
    s_mul_i32 s73, s51, 2
    s_lshr_b32 s73, s73, 1
    s_add_u32 s74, s74, s73
    s_cmp_lt_u32 s62, 2
    s_cselect_b32 s99, 10, 9
    s_cmp_ge_u32 s74, s99
    s_cselect_b32 s75, s99, 0
    s_sub_u32 s88, s74, s75
    s_add_u32 s89, s88, 1
    s_cmp_eq_u32 s89, s99
    s_cselect_b32 s89, 0, s89
    s_add_u32 s90, s89, 1
    s_cmp_eq_u32 s90, s99
    s_cselect_b32 s90, 0, s90
    s_add_u32 s91, s90, 1
    s_cmp_eq_u32 s91, s99
    s_cselect_b32 s91, 0, s91
    s_add_u32 s92, s91, 1
    s_cmp_eq_u32 s92, s99
    s_cselect_b32 s92, 0, s92
    s_add_u32 s93, s92, 1
    s_cmp_eq_u32 s93, s99
    s_cselect_b32 s93, 0, s93
    s_add_u32 s94, s93, 1
    s_cmp_eq_u32 s94, s99
    s_cselect_b32 s94, 0, s94
    s_add_u32 s95, s94, 1
    s_cmp_eq_u32 s95, s99
    s_cselect_b32 s95, 0, s95
    s_add_u32 s96, s95, 1
    s_cmp_eq_u32 s96, s99
    s_cselect_b32 s96, 0, s96
    s_add_u32 s97, s96, 1
    s_cmp_eq_u32 s97, s99
    s_cselect_b32 s97, 0, s97
    s_mul_i32 s76, s62, 9
    s_min_u32 s75, s62, 2
    s_add_u32 s76, s76, s75
    v_lshrrev_b32 v4, 1, v1
    s_sub_u32 s75, s99, 1
    v_min_u32 v4, s75, v4
    v_add_u32 v4, s76, v4
    s_mul_i32 s75, s51, 5
    s_lshr_b32 s75, s75, 2
    s_mul_i32 s75, s75, 74
    v_and_b32 v5, 1, v1
    v_mul_u32_u24 v5, 74, v5
    v_add3_u32 v4, v4, v5, s75
    v_mul_u32_u24 v4, 10923, v4
    v_lshrrev_b32 v4, 16, v4
    v_lshlrev_b32 v4, 7, v4
    v_add_u32 v21, 4198400, v4
    s_mul_i32 s75, s51, 74
    s_add_u32 s75, s75, s76
    s_mul_i32 s75, s75, 5120
    s_add_u32 s75, s75, 11534336
    s_add_u32 s24, s60, s75
    s_addc_u32 s25, s61, 0
    s_mul_i32 s26, s99, 5120
    s_mov_b32 s27, 0x00020000
    s_mul_i32 s75, s50, 74
    s_add_u32 s75, s75, s76
    s_lshl_b32 s75, s75, 12
    s_add_u32 s20, s60, s75
    s_addc_u32 s21, s61, 0
    s_lshl_b32 s22, s99, 12
    s_mov_b32 s23, 0x00020000
    s_cmp_ge_u32 s62, 2
    s_cbranch_scc1 Ly_8
    s_lshr_b32 s73, s50, 1
    s_lshl_b32 s73, s73, 7
    s_lshl_b32 s74, s62, 5
    s_add_u32 s73, s73, s74
    s_add_u32 s73, s73, 2048
    v_and_b32 v4, 3, v1
    v_lshl_add_u32 v0, v4, 3, s73
    s_branch Ly_9
Ly_8:
    s_lshl_b32 s73, s50, 6
    s_add_u32 s74, s73, 63
    s_mul_i32 s73, s73, 27595
    s_lshr_b32 s73, s73, 22
    s_mul_i32 s74, s74, 27595
    s_lshr_b32 s74, s74, 22
    s_sub_u32 s74, s74, s73
    s_lshl_b32 s74, s74, 7
    s_lshl_b32 s73, s73, 7
    s_sub_u32 s75, s62, 2
    s_mul_i32 s75, s75, 3
    s_lshr_b32 s75, s75, 1
    s_lshl_b32 s75, s75, 3
    s_add_u32 s73, s73, s75
    v_and_b32 v4, 1, v1
    v_lshlrev_b32 v4, 3, v4
    v_bfe_u32 v5, v1, 1, 1
    v_mul_u32_u24 v5, s74, v5
    v_add3_u32 v0, v4, v5, s73
Ly_9:
    v_lshlrev_b32 v0, 4, v0
    v_add_u32 v0, 4325376, v0
    s_lshl_b32 s73, s50, 6
    v_add_u32 v4, s73, v3
    v_mul_u32_u24 v4, 1280, v4
    v_lshl_add_u32 v4, v2, 3, v4
    s_mul_i32 s73, s51, 160
    v_add_u32 v10, s73, v4
    s_cmp_lt_u32 s62, 2
    s_cselect_b64 vcc, -1, 0
    v_mov_b32 v4, 0
    buffer_load_dwordx2 v[26:27], v4, s[32:35], 0 offen sc1
    s_barrier
    s_mov_b32 s69, 98304
    s_add_u32 m0, s69, s72
    s_add_u32 s12, s12, 128
    buffer_load_dwordx4 v11, s[4:7], s12 offen lds
    buffer_load_dwordx4 v12, s[4:7], s12 offen offset:1024 lds
    s_cbranch_vccz Lsk_10
    s_add_u32 m0, s69, s14
    s_add_u32 s13, s13, 128
    buffer_load_dwordx4 v124, s[4:7], s13 offen lds
Lsk_10:
    s_add_u32 m0, s69, s47
    s_add_u32 s67, s67, 245760
    buffer_load_dwordx4 v120, s[8:11], s67 offen offset:0 lds
    s_waitcnt vmcnt(4)
    s_barrier
    ds_read_b128 v[136:139], v13 offset:0
    ds_read_b128 v[140:143], v13 offset:2048
    ds_read_b128 v[144:147], v13 offset:4096
    ds_read_b128 v[148:151], v13 offset:6144
    s_mov_b64 exec, s[84:85]
    ds_read_b128 v[168:171], v15
    s_mov_b64 exec, -1
    ds_read_b64_tr_b16 v[176:177], v17 offset:0
    ds_read_b64_tr_b16 v[178:179], v17 offset:3840
    ds_read_b64_tr_b16 v[180:181], v18 offset:0
    ds_read_b64_tr_b16 v[182:183], v18 offset:3840
    ds_read_b64_tr_b16 v[184:185], v19 offset:0
    ds_read_b64_tr_b16 v[186:187], v19 offset:3840
    ds_read_b64_tr_b16 v[188:189], v20 offset:0
    ds_read_b64_tr_b16 v[190:191], v20 offset:3840
    s_mov_b32 s71, 49152
    s_waitcnt lgkmcnt(0)
    v_mfma_f32_16x16x32_bf16 v[48:51], v[176:179], v[136:139], 0
    s_setprio 1
    s_add_u32 s74, s71, 49152
    s_cmp_eq_u32 s74, 147456
    s_cselect_b32 s74, 0, s74
    buffer_load_dwordx4 v121, s[8:11], s67 offen offset:1024 lds
    buffer_load_dwordx4 v122, s[8:11], s67 offen offset:2048 lds
    ds_read_b128 v[152:155], v14 offset:0
    ds_read_b128 v[156:159], v14 offset:2048
    v_mfma_f32_16x16x32_bf16 v[52:55], v[176:179], v[140:143], 0
    s_sub_u32 s70, s74, s71
    s_mov_b64 exec, s[100:101]
    buffer_load_dwordx4 v123, s[8:11], s67 offen offset:3072 lds
    s_mov_b64 exec, -1
    ds_read_b128 v[160:163], v14 offset:4096
    v_mfma_f32_16x16x32_bf16 v[56:59], v[176:179], v[144:147], 0
    ds_read_b128 v[164:167], v14 offset:6144
    v_mfma_f32_16x16x32_bf16 v[60:63], v[176:179], v[148:151], 0
    s_mov_b32 s69, 0
    s_mov_b64 exec, s[84:85]
    ds_read_b128 v[172:175], v16
    s_mov_b64 exec, -1
    v_mfma_f32_16x16x32_bf16 v[112:115], v[176:179], v[168:171], 0
    s_add_u32 m0, s69, s72
    s_add_u32 s12, s12, 128
    v_mfma_f32_16x16x32_bf16 v[64:67], v[180:183], v[136:139], 0
    buffer_load_dwordx4 v11, s[4:7], s12 offen lds
    v_add_u32 v14, s70, v14
    v_mfma_f32_16x16x32_bf16 v[68:71], v[180:183], v[140:143], 0
    buffer_load_dwordx4 v12, s[4:7], s12 offen offset:1024 lds
    s_cbranch_vccz Lsk_11
    s_add_u32 m0, s69, s14
    s_add_u32 s13, s13, 128
    buffer_load_dwordx4 v124, s[4:7], s13 offen lds
Lsk_11:
    v_add_u32 v16, s70, v16
    ds_read_b64_tr_b16 v[192:193], v17 offset:15360
    v_mfma_f32_16x16x32_bf16 v[72:75], v[180:183], v[144:147], 0
    ds_read_b64_tr_b16 v[194:195], v17 offset:19200
    v_mfma_f32_16x16x32_bf16 v[76:79], v[180:183], v[148:151], 0
    ds_read_b64_tr_b16 v[196:197], v18 offset:15360
    v_mfma_f32_16x16x32_bf16 v[116:119], v[180:183], v[168:171], 0
    s_setprio 0
    ds_read_b64_tr_b16 v[198:199], v18 offset:19200
    v_add_u32 v17, s70, v17
    v_mfma_f32_16x16x32_bf16 v[80:83], v[184:187], v[136:139], 0
    s_add_u32 m0, s69, s47
    s_add_u32 s67, s67, 245760
    ds_read_b64_tr_b16 v[200:201], v19 offset:15360
    v_mfma_f32_16x16x32_bf16 v[84:87], v[184:187], v[140:143], 0
    buffer_load_dwordx4 v120, s[8:11], s67 offen offset:0 lds
    ds_read_b64_tr_b16 v[202:203], v19 offset:19200
    v_mfma_f32_16x16x32_bf16 v[88:91], v[184:187], v[144:147], 0
    buffer_load_dwordx4 v121, s[8:11], s67 offen offset:1024 lds
    buffer_load_dwordx4 v122, s[8:11], s67 offen offset:2048 lds
    v_add_u32 v18, s70, v18
    ds_read_b64_tr_b16 v[204:205], v20 offset:15360
    v_mfma_f32_16x16x32_bf16 v[92:95], v[184:187], v[148:151], 0
    s_mov_b64 exec, s[100:101]
    buffer_load_dwordx4 v123, s[8:11], s67 offen offset:3072 lds
    s_mov_b64 exec, -1
    ds_read_b64_tr_b16 v[206:207], v20 offset:19200
    v_mfma_f32_16x16x32_bf16 v[96:99], v[188:191], v[136:139], 0
    v_add_u32 v19, s70, v19
    v_mfma_f32_16x16x32_bf16 v[100:103], v[188:191], v[140:143], 0
    s_mov_b32 s69, s71
    v_add_u32 v20, s70, v20
    v_add_u32 v13, s70, v13
    v_mfma_f32_16x16x32_bf16 v[104:107], v[188:191], v[144:147], 0
    s_mov_b32 s71, s74
    v_add_u32 v15, s70, v15
    v_mfma_f32_16x16x32_bf16 v[108:111], v[188:191], v[148:151], 0
    s_waitcnt vmcnt(6) lgkmcnt(0)
    s_barrier
    s_setprio 3
    v_mfma_f32_16x16x32_bf16 v[48:51], v[192:195], v[152:155], v[48:51]
    s_bitcmp1_b32 16, s65
    s_cbranch_scc0 Ldu_12
    s_cmp_ge_u32 s46, s87
    s_cbranch_scc1 Ldu_12
    buffer_load_dword v255, v254, s[36:39], s46 offen
    s_add_u32 s46, s46, s86
    s_cmp_ge_u32 s46, s87
    s_cbranch_scc1 Ldu_12
    buffer_load_dword v255, v254, s[36:39], s46 offen
    s_add_u32 s46, s46, s86
Ldu_12:
    ds_read_b128 v[136:139], v13 offset:0
    v_mfma_f32_16x16x32_bf16 v[52:55], v[192:195], v[156:159], v[52:55]
    ds_read_b128 v[140:143], v13 offset:2048
    v_mfma_f32_16x16x32_bf16 v[56:59], v[192:195], v[160:163], v[56:59]
    ds_read_b128 v[144:147], v13 offset:4096
    v_mfma_f32_16x16x32_bf16 v[60:63], v[192:195], v[164:167], v[60:63]
    ds_read_b128 v[148:151], v13 offset:6144
    v_mfma_f32_16x16x32_bf16 v[112:115], v[192:195], v[172:175], v[112:115]
    s_mov_b64 exec, s[84:85]
    ds_read_b128 v[168:171], v15
    s_mov_b64 exec, -1
    v_mfma_f32_16x16x32_bf16 v[64:67], v[196:199], v[152:155], v[64:67]
    v_mfma_f32_16x16x32_bf16 v[68:71], v[196:199], v[156:159], v[68:71]
    v_mfma_f32_16x16x32_bf16 v[72:75], v[196:199], v[160:163], v[72:75]
    s_add_u32 m0, s69, s72
    s_add_u32 s12, s12, 128
    ds_read_b64_tr_b16 v[176:177], v17 offset:0
    v_mfma_f32_16x16x32_bf16 v[76:79], v[196:199], v[164:167], v[76:79]
    ds_read_b64_tr_b16 v[178:179], v17 offset:3840
    v_mfma_f32_16x16x32_bf16 v[116:119], v[196:199], v[172:175], v[116:119]
    buffer_load_dwordx4 v11, s[4:7], s12 offen lds
    buffer_load_dwordx4 v12, s[4:7], s12 offen offset:1024 lds
    ds_read_b64_tr_b16 v[180:181], v18 offset:0
    s_setprio 2
    v_mfma_f32_16x16x32_bf16 v[80:83], v[200:203], v[152:155], v[80:83]
    s_cbranch_vccz Lsk_13
    s_add_u32 m0, s69, s14
    s_add_u32 s13, s13, 128
    buffer_load_dwordx4 v124, s[4:7], s13 offen lds
Lsk_13:
    ds_read_b64_tr_b16 v[182:183], v18 offset:3840
    v_mfma_f32_16x16x32_bf16 v[84:87], v[200:203], v[156:159], v[84:87]
    ds_read_b64_tr_b16 v[184:185], v19 offset:0
    v_mfma_f32_16x16x32_bf16 v[88:91], v[200:203], v[160:163], v[88:91]
    ds_read_b64_tr_b16 v[186:187], v19 offset:3840
    v_mfma_f32_16x16x32_bf16 v[92:95], v[200:203], v[164:167], v[92:95]
    s_add_u32 m0, s69, s47
    s_add_u32 s67, s67, 245760
    ds_read_b64_tr_b16 v[188:189], v20 offset:0
    v_mfma_f32_16x16x32_bf16 v[96:99], v[204:207], v[152:155], v[96:99]
    ds_read_b64_tr_b16 v[190:191], v20 offset:3840
    v_mfma_f32_16x16x32_bf16 v[100:103], v[204:207], v[156:159], v[100:103]
    buffer_load_dwordx4 v120, s[8:11], s67 offen offset:0 lds
    v_mfma_f32_16x16x32_bf16 v[104:107], v[204:207], v[160:163], v[104:107]
    v_mfma_f32_16x16x32_bf16 v[108:111], v[204:207], v[164:167], v[108:111]
    s_mov_b32 s98, 0
Lno_14:
    v_readfirstlane_b32 s82, v26
    v_readfirstlane_b32 s83, v27
    s_add_u32 s98, s98, 1
    s_cmp_gt_u32 s98, 100000
    s_cbranch_scc1 Lno_15
    s_cmp_lg_u32 s82, 0
    s_cbranch_scc1 Lno_15
    v_mov_b32 v4, 0
    buffer_load_dwordx2 v[26:27], v4, s[32:35], 0 offen sc1
    s_waitcnt vmcnt(0)
    s_branch Lno_14
Lno_15:
    s_mov_b32 s65, 1
Lloop_q:
    s_waitcnt lgkmcnt(0)
    v_mfma_f32_16x16x32_bf16 v[48:51], v[176:179], v[136:139], v[48:51]
    s_setprio 1
    s_add_u32 s74, s71, 49152
    s_cmp_eq_u32 s74, 147456
    s_cselect_b32 s74, 0, s74
    ds_read_b128 v[152:155], v14 offset:0
    ds_read_b128 v[156:159], v14 offset:2048
    v_mfma_f32_16x16x32_bf16 v[52:55], v[176:179], v[140:143], v[52:55]
    s_sub_u32 s70, s74, s71
    ds_read_b128 v[160:163], v14 offset:4096
    v_mfma_f32_16x16x32_bf16 v[56:59], v[176:179], v[144:147], v[56:59]
    buffer_load_dwordx4 v121, s[8:11], s67 offen offset:1024 lds
    ds_read_b128 v[164:167], v14 offset:6144
    v_mfma_f32_16x16x32_bf16 v[60:63], v[176:179], v[148:151], v[60:63]
    s_mov_b64 exec, s[84:85]
    ds_read_b128 v[172:175], v16
    s_mov_b64 exec, -1
    v_mfma_f32_16x16x32_bf16 v[112:115], v[176:179], v[168:171], v[112:115]
    buffer_load_dwordx4 v122, s[8:11], s67 offen offset:2048 lds
    v_mfma_f32_16x16x32_bf16 v[64:67], v[180:183], v[136:139], v[64:67]
    v_add_u32 v14, s70, v14
    v_mfma_f32_16x16x32_bf16 v[68:71], v[180:183], v[140:143], v[68:71]
    s_mov_b64 exec, s[100:101]
    buffer_load_dwordx4 v123, s[8:11], s67 offen offset:3072 lds
    s_mov_b64 exec, -1
    v_add_u32 v16, s70, v16
    ds_read_b64_tr_b16 v[192:193], v17 offset:15360
    v_mfma_f32_16x16x32_bf16 v[72:75], v[180:183], v[144:147], v[72:75]
    ds_read_b64_tr_b16 v[194:195], v17 offset:19200
    v_mfma_f32_16x16x32_bf16 v[76:79], v[180:183], v[148:151], v[76:79]
    ds_read_b64_tr_b16 v[196:197], v18 offset:15360
    v_mfma_f32_16x16x32_bf16 v[116:119], v[180:183], v[168:171], v[116:119]
    s_setprio 0
    ds_read_b64_tr_b16 v[198:199], v18 offset:19200
    v_add_u32 v17, s70, v17
    v_mfma_f32_16x16x32_bf16 v[80:83], v[184:187], v[136:139], v[80:83]
    ds_read_b64_tr_b16 v[200:201], v19 offset:15360
    v_mfma_f32_16x16x32_bf16 v[84:87], v[184:187], v[140:143], v[84:87]
    ds_read_b64_tr_b16 v[202:203], v19 offset:19200
    v_mfma_f32_16x16x32_bf16 v[88:91], v[184:187], v[144:147], v[88:91]
    s_mov_b32 s69, s71
    v_add_u32 v18, s70, v18
    ds_read_b64_tr_b16 v[204:205], v20 offset:15360
    v_mfma_f32_16x16x32_bf16 v[92:95], v[184:187], v[148:151], v[92:95]
    ds_read_b64_tr_b16 v[206:207], v20 offset:19200
    v_mfma_f32_16x16x32_bf16 v[96:99], v[188:191], v[136:139], v[96:99]
    s_mov_b32 s71, s74
    v_add_u32 v19, s70, v19
    v_mfma_f32_16x16x32_bf16 v[100:103], v[188:191], v[140:143], v[100:103]
    v_add_u32 v20, s70, v20
    v_add_u32 v13, s70, v13
    v_mfma_f32_16x16x32_bf16 v[104:107], v[188:191], v[144:147], v[104:107]
    v_add_u32 v15, s70, v15
    v_mfma_f32_16x16x32_bf16 v[108:111], v[188:191], v[148:151], v[108:111]
    s_waitcnt vmcnt(6) lgkmcnt(0)
    s_barrier
    s_setprio 3
    v_mfma_f32_16x16x32_bf16 v[48:51], v[192:195], v[152:155], v[48:51]
    s_bitcmp1_b32 16, s65
    s_cbranch_scc0 Ldu_18
    s_cmp_ge_u32 s46, s87
    s_cbranch_scc1 Ldu_18
    buffer_load_dword v255, v254, s[36:39], s46 offen
    s_add_u32 s46, s46, s86
    s_cmp_ge_u32 s46, s87
    s_cbranch_scc1 Ldu_18
    buffer_load_dword v255, v254, s[36:39], s46 offen
    s_add_u32 s46, s46, s86
Ldu_18:
    ds_read_b128 v[136:139], v13 offset:0
    v_mfma_f32_16x16x32_bf16 v[52:55], v[192:195], v[156:159], v[52:55]
    ds_read_b128 v[140:143], v13 offset:2048
    v_mfma_f32_16x16x32_bf16 v[56:59], v[192:195], v[160:163], v[56:59]
    ds_read_b128 v[144:147], v13 offset:4096
    v_mfma_f32_16x16x32_bf16 v[60:63], v[192:195], v[164:167], v[60:63]
    ds_read_b128 v[148:151], v13 offset:6144
    v_mfma_f32_16x16x32_bf16 v[112:115], v[192:195], v[172:175], v[112:115]
    s_mov_b64 exec, s[84:85]
    ds_read_b128 v[168:171], v15
    s_mov_b64 exec, -1
    v_mfma_f32_16x16x32_bf16 v[64:67], v[196:199], v[152:155], v[64:67]
    v_mfma_f32_16x16x32_bf16 v[68:71], v[196:199], v[156:159], v[68:71]
    v_mfma_f32_16x16x32_bf16 v[72:75], v[196:199], v[160:163], v[72:75]
    s_add_u32 m0, s69, s72
    s_add_u32 s12, s12, 128
    ds_read_b64_tr_b16 v[176:177], v17 offset:0
    v_mfma_f32_16x16x32_bf16 v[76:79], v[196:199], v[164:167], v[76:79]
    ds_read_b64_tr_b16 v[178:179], v17 offset:3840
    v_mfma_f32_16x16x32_bf16 v[116:119], v[196:199], v[172:175], v[116:119]
    buffer_load_dwordx4 v11, s[4:7], s12 offen lds
    buffer_load_dwordx4 v12, s[4:7], s12 offen offset:1024 lds
    ds_read_b64_tr_b16 v[180:181], v18 offset:0
    s_setprio 2
    v_mfma_f32_16x16x32_bf16 v[80:83], v[200:203], v[152:155], v[80:83]
    s_cbranch_vccz Lsk_19
    s_add_u32 m0, s69, s14
    s_add_u32 s13, s13, 128
    buffer_load_dwordx4 v124, s[4:7], s13 offen lds
Lsk_19:
    ds_read_b64_tr_b16 v[182:183], v18 offset:3840
    v_mfma_f32_16x16x32_bf16 v[84:87], v[200:203], v[156:159], v[84:87]
    ds_read_b64_tr_b16 v[184:185], v19 offset:0
    v_mfma_f32_16x16x32_bf16 v[88:91], v[200:203], v[160:163], v[88:91]
    ds_read_b64_tr_b16 v[186:187], v19 offset:3840
    v_mfma_f32_16x16x32_bf16 v[92:95], v[200:203], v[164:167], v[92:95]
    s_add_u32 m0, s69, s47
    s_add_u32 s67, s67, 245760
    ds_read_b64_tr_b16 v[188:189], v20 offset:0
    v_mfma_f32_16x16x32_bf16 v[96:99], v[204:207], v[152:155], v[96:99]
    ds_read_b64_tr_b16 v[190:191], v20 offset:3840
    v_mfma_f32_16x16x32_bf16 v[100:103], v[204:207], v[156:159], v[100:103]
    buffer_load_dwordx4 v120, s[8:11], s67 offen offset:0 lds
    s_bitcmp1_b32 40, s65
    s_cbranch_scc1 Lspec_q
Lret_q:
    v_mfma_f32_16x16x32_bf16 v[104:107], v[204:207], v[160:163], v[104:107]
    s_add_u32 s65, s65, 1
    s_cmp_lt_u32 s65, 7
    v_mfma_f32_16x16x32_bf16 v[108:111], v[204:207], v[164:167], v[108:111]
    s_cbranch_scc1 Lloop_q
    s_branch Lpost_q
Lspec_q:
    s_cmp_lg_u32 s65, 3
    s_cbranch_scc1 Ls_20
    s_cmp_lt_u32 s62, 4
    s_cbranch_scc1 Lsl_22
    s_and_b32 s73, s2, 1
    s_lshl_b32 s73, s73, 10
    s_bfe_u32 s75, s2, 0x20001
    s_lshl_b32 s75, s75, 8
    s_add_u32 s73, s73, s75
    s_and_b32 s75, s2, 0x78
    s_lshl_b32 s75, s75, 1
    s_add_u32 s73, s73, s75
    s_sub_u32 s75, s62, 4
    s_lshl_b32 s75, s75, 2
    s_add_u32 s73, s73, s75
    s_mul_i32 s73, s73, 1280
    v_mul_u32_u24 v4, 1280, v2
    v_lshl_add_u32 v4, v3, 4, v4
    buffer_load_dwordx4 v[232:235], v4, s[4:7], s73 offen offset:0
    buffer_load_dwordx4 v[236:239], v4, s[4:7], s73 offen offset:256
    buffer_load_dwordx4 v[240:243], v4, s[4:7], s73 offen offset:512
    buffer_load_dwordx4 v[244:247], v4, s[4:7], s73 offen offset:768
    buffer_load_dwordx4 v[248:251], v4, s[4:7], s73 offen offset:1024
Lsl_22:
Ls_20:
    s_cmp_lg_u32 s65, 5
    s_cbranch_scc1 Ls_21
    s_cmp_lt_u32 s62, 4
    s_cbranch_scc1 Ltw_23
    v_mov_b32 v252, 0
    v_mov_b32 v253, 0
    v_mov_b32 v4, 0x3f803f80
    v_dot2c_f32_bf16 v252, v232, v4
    v_dot2c_f32_bf16 v253, v232, v232
    v_dot2c_f32_bf16 v252, v233, v4
    v_dot2c_f32_bf16 v253, v233, v233
    v_dot2c_f32_bf16 v252, v234, v4
    v_dot2c_f32_bf16 v253, v234, v234
    v_dot2c_f32_bf16 v252, v235, v4
    v_dot2c_f32_bf16 v253, v235, v235
    v_dot2c_f32_bf16 v252, v236, v4
    v_dot2c_f32_bf16 v253, v236, v236
    v_dot2c_f32_bf16 v252, v237, v4
    v_dot2c_f32_bf16 v253, v237, v237
    v_dot2c_f32_bf16 v252, v238, v4
    v_dot2c_f32_bf16 v253, v238, v238
    v_dot2c_f32_bf16 v252, v239, v4
    v_dot2c_f32_bf16 v253, v239, v239
    v_dot2c_f32_bf16 v252, v240, v4
    v_dot2c_f32_bf16 v253, v240, v240
    v_dot2c_f32_bf16 v252, v241, v4
    v_dot2c_f32_bf16 v253, v241, v241
    v_dot2c_f32_bf16 v252, v242, v4
    v_dot2c_f32_bf16 v253, v242, v242
    v_dot2c_f32_bf16 v252, v243, v4
    v_dot2c_f32_bf16 v253, v243, v243
    v_dot2c_f32_bf16 v252, v244, v4
    v_dot2c_f32_bf16 v253, v244, v244
    v_dot2c_f32_bf16 v252, v245, v4
    v_dot2c_f32_bf16 v253, v245, v245
    v_dot2c_f32_bf16 v252, v246, v4
    v_dot2c_f32_bf16 v253, v246, v246
    v_dot2c_f32_bf16 v252, v247, v4
    v_dot2c_f32_bf16 v253, v247, v247
    v_dot2c_f32_bf16 v252, v248, v4
    v_dot2c_f32_bf16 v253, v248, v248
    v_dot2c_f32_bf16 v252, v249, v4
    v_dot2c_f32_bf16 v253, v249, v249
    v_dot2c_f32_bf16 v252, v250, v4
    v_dot2c_f32_bf16 v253, v250, v250
    v_dot2c_f32_bf16 v252, v251, v4
    v_dot2c_f32_bf16 v253, v251, v251
    s_nop 2
    v_add_f32_dpp v252, v252, v252 row_ror:8 row_mask:0xf bank_mask:0xf
    v_add_f32_dpp v253, v253, v253 row_ror:8 row_mask:0xf bank_mask:0xf
    s_nop 0
    v_add_f32_dpp v252, v252, v252 row_ror:4 row_mask:0xf bank_mask:0xf
    v_add_f32_dpp v253, v253, v253 row_ror:4 row_mask:0xf bank_mask:0xf
    s_nop 0
    v_add_f32_dpp v252, v252, v252 row_ror:2 row_mask:0xf bank_mask:0xf
    v_add_f32_dpp v253, v253, v253 row_ror:2 row_mask:0xf bank_mask:0xf
    s_nop 0
    v_add_f32_dpp v252, v252, v252 row_ror:1 row_mask:0xf bank_mask:0xf
    v_add_f32_dpp v253, v253, v253 row_ror:1 row_mask:0xf bank_mask:0xf
    s_nop 0
    v_mul_f32 v252, 0x3acccccd, v252
    v_mul_f32 v253, 0x3acccccd, v253
    v_fma_f32 v253, -v252, v252, v253
    v_max_f32 v253, 0, v253
    v_cvt_pk_bf16_f32 v4, v252, v253
    v_lshlrev_b32 v5, 16, v4
    v_and_b32 v253, 0xffff0000, v4
    v_add_f32 v253, 0x3727c5ac, v253
    v_cvt_pk_bf16_f32 v253, v253, v253
    v_and_b32 v253, 0xffff0000, v253
    v_sqrt_f32 v253, v253
    s_nop 0
    v_cvt_pk_bf16_f32 v253, v253, v253
    v_and_b32 v253, 0xffff0000, v253
    v_rcp_f32 v252, v253
    s_nop 0
    v_mul_f32 v253, v5, v252
    v_sub_f32 v253, 0, v253
    v_mov_b32 v232, v252
    v_mov_b32 v233, v253
    v_mov_b32 v234, s82
    v_mov_b32 v235, s83
    s_and_b32 s73, s2, 1
    s_lshl_b32 s73, s73, 10
    s_bfe_u32 s75, s2, 0x20001
    s_lshl_b32 s75, s75, 8
    s_add_u32 s73, s73, s75
    s_and_b32 s75, s2, 0x78
    s_lshl_b32 s75, s75, 1
    s_add_u32 s73, s73, s75
    s_sub_u32 s75, s62, 4
    s_lshl_b32 s75, s75, 2
    s_add_u32 s73, s73, s75
    s_lshl_b32 s73, s73, 5
    s_add_u32 s73, s73, 4456448
    v_lshlrev_b32 v4, 5, v2
    v_lshl_add_u32 v4, v3, 4, v4
    s_mov_b32 exec_lo, 196611
    s_mov_b32 exec_hi, 196611
    buffer_store_dwordx4 v[232:235], v4, s[28:31], s73 offen sc1
    s_mov_b64 exec, -1
Ltw_23:
Ls_21:
    s_cmp_lg_u32 s65, 5
    s_cbranch_scc1 Lret_q
    buffer_load_dwordx2 v[26:27], v21, s[28:31], 0 offen sc1
    s_branch Lret_q
Lpost_q:
    s_waitcnt lgkmcnt(0)
    v_mfma_f32_16x16x32_bf16 v[48:51], v[176:179], v[136:139], v[48:51]
    s_setprio 1
    s_add_u32 s74, s71, 49152
    s_cmp_eq_u32 s74, 147456
    s_cselect_b32 s74, 0, s74
    ds_read_b128 v[152:155], v14 offset:0
    ds_read_b128 v[156:159], v14 offset:2048
    v_mfma_f32_16x16x32_bf16 v[52:55], v[176:179], v[140:143], v[52:55]
    s_sub_u32 s70, s74, s71
    ds_read_b128 v[160:163], v14 offset:4096
    v_mfma_f32_16x16x32_bf16 v[56:59], v[176:179], v[144:147], v[56:59]
    buffer_load_dwordx4 v121, s[8:11], s67 offen offset:1024 lds
    ds_read_b128 v[164:167], v14 offset:6144
    v_mfma_f32_16x16x32_bf16 v[60:63], v[176:179], v[148:151], v[60:63]
    s_mov_b64 exec, s[84:85]
    ds_read_b128 v[172:175], v16
    s_mov_b64 exec, -1
    v_mfma_f32_16x16x32_bf16 v[112:115], v[176:179], v[168:171], v[112:115]
    buffer_load_dwordx4 v122, s[8:11], s67 offen offset:2048 lds
    v_mfma_f32_16x16x32_bf16 v[64:67], v[180:183], v[136:139], v[64:67]
    v_add_u32 v14, s70, v14
    v_mfma_f32_16x16x32_bf16 v[68:71], v[180:183], v[140:143], v[68:71]
    v_add_u32 v16, s70, v16
    ds_read_b64_tr_b16 v[192:193], v17 offset:15360
    v_mfma_f32_16x16x32_bf16 v[72:75], v[180:183], v[144:147], v[72:75]
    s_mov_b64 exec, s[100:101]
    buffer_load_dwordx4 v123, s[8:11], s67 offen offset:3072 lds
    s_mov_b64 exec, -1
    ds_read_b64_tr_b16 v[194:195], v17 offset:19200
    v_mfma_f32_16x16x32_bf16 v[76:79], v[180:183], v[148:151], v[76:79]
    ds_read_b64_tr_b16 v[196:197], v18 offset:15360
    v_mfma_f32_16x16x32_bf16 v[116:119], v[180:183], v[168:171], v[116:119]
    s_setprio 0
    ds_read_b64_tr_b16 v[198:199], v18 offset:19200
    v_add_u32 v17, s70, v17
    v_mfma_f32_16x16x32_bf16 v[80:83], v[184:187], v[136:139], v[80:83]
    ds_read_b64_tr_b16 v[200:201], v19 offset:15360
    v_mfma_f32_16x16x32_bf16 v[84:87], v[184:187], v[140:143], v[84:87]
    ds_read_b64_tr_b16 v[202:203], v19 offset:19200
    v_mfma_f32_16x16x32_bf16 v[88:91], v[184:187], v[144:147], v[88:91]
    v_add_u32 v18, s70, v18
    ds_read_b64_tr_b16 v[204:205], v20 offset:15360
    v_mfma_f32_16x16x32_bf16 v[92:95], v[184:187], v[148:151], v[92:95]
    ds_read_b64_tr_b16 v[206:207], v20 offset:19200
    v_mfma_f32_16x16x32_bf16 v[96:99], v[188:191], v[136:139], v[96:99]
    s_mov_b32 s71, s74
    v_add_u32 v19, s70, v19
    v_mfma_f32_16x16x32_bf16 v[100:103], v[188:191], v[140:143], v[100:103]
    v_add_u32 v20, s70, v20
    v_add_u32 v13, s70, v13
    v_mfma_f32_16x16x32_bf16 v[104:107], v[188:191], v[144:147], v[104:107]
    v_add_u32 v15, s70, v15
    v_mfma_f32_16x16x32_bf16 v[108:111], v[188:191], v[148:151], v[108:111]
    s_waitcnt vmcnt(6) lgkmcnt(0)
    s_barrier
    s_setprio 3
    s_mov_b32 s98, 0
    s_branch Lpo_26
Lpo_24:
    buffer_load_dwordx2 v[26:27], v21, s[28:31], 0 offen sc1
    s_waitcnt vmcnt(0)
Lpo_26:
    v_cmp_eq_u64 vcc, s[82:83], v[26:27]
    s_add_u32 s98, s98, 1
    s_cmp_gt_u32 s98, 100000
    s_cbranch_scc1 Lpo_25
    s_cmp_eq_u64 vcc, -1
    s_cbranch_scc0 Lpo_24
Lpo_25:
    s_lshl_b32 s69, s62, 13
    s_add_u32 s69, s69, 98304
    s_mul_i32 s3, s62, 12288
    v_mfma_f32_16x16x32_bf16 v[48:51], v[192:195], v[152:155], v[48:51]
    s_mul_i32 s68, s91, 5120
    ds_read_b128 v[136:139], v13 offset:0
    v_mfma_f32_16x16x32_bf16 v[52:55], v[192:195], v[156:159], v[52:55]
    ds_read_b128 v[140:143], v13 offset:2048
    v_mfma_f32_16x16x32_bf16 v[56:59], v[192:195], v[160:163], v[56:59]
    ds_read_b128 v[144:147], v13 offset:4096
    v_mfma_f32_16x16x32_bf16 v[60:63], v[192:195], v[164:167], v[60:63]
    ds_read_b128 v[148:151], v13 offset:6144
    v_mfma_f32_16x16x32_bf16 v[112:115], v[192:195], v[172:175], v[112:115]
    buffer_load_dwordx4 v[216:219], v9, s[24:27], s68 offen offset:0 sc1
    s_mov_b64 exec, s[84:85]
    ds_read_b128 v[168:171], v15
    s_mov_b64 exec, -1
    v_mfma_f32_16x16x32_bf16 v[64:67], v[196:199], v[152:155], v[64:67]
    v_mfma_f32_16x16x32_bf16 v[68:71], v[196:199], v[156:159], v[68:71]
    v_mfma_f32_16x16x32_bf16 v[72:75], v[196:199], v[160:163], v[72:75]
    ds_read_b64_tr_b16 v[176:177], v17 offset:0
    v_mfma_f32_16x16x32_bf16 v[76:79], v[196:199], v[164:167], v[76:79]
    s_mul_i32 s68, s91, 5120
    ds_read_b64_tr_b16 v[178:179], v17 offset:3840
    v_mfma_f32_16x16x32_bf16 v[116:119], v[196:199], v[172:175], v[116:119]
    ds_read_b64_tr_b16 v[180:181], v18 offset:0
    s_setprio 2
    v_mfma_f32_16x16x32_bf16 v[80:83], v[200:203], v[152:155], v[80:83]
    ds_read_b64_tr_b16 v[182:183], v18 offset:3840
    v_mfma_f32_16x16x32_bf16 v[84:87], v[200:203], v[156:159], v[84:87]
    ds_read_b64_tr_b16 v[184:185], v19 offset:0
    v_mfma_f32_16x16x32_bf16 v[88:91], v[200:203], v[160:163], v[88:91]
    buffer_load_dwordx4 v[220:223], v9, s[24:27], s68 offen offset:1024 sc1
    ds_read_b64_tr_b16 v[186:187], v19 offset:3840
    v_mfma_f32_16x16x32_bf16 v[92:95], v[200:203], v[164:167], v[92:95]
    ds_read_b64_tr_b16 v[188:189], v20 offset:0
    v_mfma_f32_16x16x32_bf16 v[96:99], v[204:207], v[152:155], v[96:99]
    ds_read_b64_tr_b16 v[190:191], v20 offset:3840
    v_mfma_f32_16x16x32_bf16 v[100:103], v[204:207], v[156:159], v[100:103]
    v_mfma_f32_16x16x32_bf16 v[104:107], v[204:207], v[160:163], v[104:107]
    v_mfma_f32_16x16x32_bf16 v[108:111], v[204:207], v[164:167], v[108:111]
    s_add_u32 s65, s65, 1
    s_waitcnt lgkmcnt(0)
    v_mfma_f32_16x16x32_bf16 v[48:51], v[176:179], v[136:139], v[48:51]
    s_setprio 1
    s_add_u32 s74, s71, 49152
    s_cmp_eq_u32 s74, 147456
    s_cselect_b32 s74, 0, s74
    ds_read_b128 v[152:155], v14 offset:0
    ds_read_b128 v[156:159], v14 offset:2048
    v_mfma_f32_16x16x32_bf16 v[52:55], v[176:179], v[140:143], v[52:55]
    s_sub_u32 s70, s74, s71
    ds_read_b128 v[160:163], v14 offset:4096
    v_mfma_f32_16x16x32_bf16 v[56:59], v[176:179], v[144:147], v[56:59]
    s_mul_i32 s68, s91, 5120
    ds_read_b128 v[164:167], v14 offset:6144
    v_mfma_f32_16x16x32_bf16 v[60:63], v[176:179], v[148:151], v[60:63]
    s_mov_b64 exec, s[84:85]
    ds_read_b128 v[172:175], v16
    s_mov_b64 exec, -1
    v_mfma_f32_16x16x32_bf16 v[112:115], v[176:179], v[168:171], v[112:115]
    v_mfma_f32_16x16x32_bf16 v[64:67], v[180:183], v[136:139], v[64:67]
    buffer_load_dwordx4 v[224:227], v9, s[24:27], s68 offen offset:2048 sc1
    v_add_u32 v14, s70, v14
    v_mfma_f32_16x16x32_bf16 v[68:71], v[180:183], v[140:143], v[68:71]
    v_add_u32 v16, s70, v16
    ds_read_b64_tr_b16 v[192:193], v17 offset:15360
    v_mfma_f32_16x16x32_bf16 v[72:75], v[180:183], v[144:147], v[72:75]
    ds_read_b64_tr_b16 v[194:195], v17 offset:19200
    v_mfma_f32_16x16x32_bf16 v[76:79], v[180:183], v[148:151], v[76:79]
    s_mul_i32 s68, s91, 5120
    ds_read_b64_tr_b16 v[196:197], v18 offset:15360
    v_mfma_f32_16x16x32_bf16 v[116:119], v[180:183], v[168:171], v[116:119]
    s_setprio 0
    ds_read_b64_tr_b16 v[198:199], v18 offset:19200
    v_add_u32 v17, s70, v17
    v_mfma_f32_16x16x32_bf16 v[80:83], v[184:187], v[136:139], v[80:83]
    ds_read_b64_tr_b16 v[200:201], v19 offset:15360
    v_mfma_f32_16x16x32_bf16 v[84:87], v[184:187], v[140:143], v[84:87]
    buffer_load_dwordx4 v[228:231], v9, s[24:27], s68 offen offset:3072 sc1
    ds_read_b64_tr_b16 v[202:203], v19 offset:19200
    v_mfma_f32_16x16x32_bf16 v[88:91], v[184:187], v[144:147], v[88:91]
    v_add_u32 v18, s70, v18
    ds_read_b64_tr_b16 v[204:205], v20 offset:15360
    v_mfma_f32_16x16x32_bf16 v[92:95], v[184:187], v[148:151], v[92:95]
    ds_read_b64_tr_b16 v[206:207], v20 offset:19200
    v_mfma_f32_16x16x32_bf16 v[96:99], v[188:191], v[136:139], v[96:99]
    s_mov_b32 s71, s74
    v_add_u32 v19, s70, v19
    v_mfma_f32_16x16x32_bf16 v[100:103], v[188:191], v[140:143], v[100:103]
    v_add_u32 v20, s70, v20
    v_add_u32 v13, s70, v13
    v_mfma_f32_16x16x32_bf16 v[104:107], v[188:191], v[144:147], v[104:107]
    v_add_u32 v15, s70, v15
    v_mfma_f32_16x16x32_bf16 v[108:111], v[188:191], v[148:151], v[108:111]
    s_waitcnt vmcnt(4) lgkmcnt(0)
    s_barrier
    s_setprio 3
    v_mfma_f32_16x16x32_bf16 v[48:51], v[192:195], v[152:155], v[48:51]
    buffer_load_dwordx4 v[28:31], v22, s[28:31], s48 offen offset:0 sc1
    ds_read_b128 v[136:139], v13 offset:0
    v_mfma_f32_16x16x32_bf16 v[52:55], v[192:195], v[156:159], v[52:55]
    buffer_load_dwordx4 v[32:35], v22, s[28:31], s48 offen offset:512 sc1
    ds_read_b128 v[140:143], v13 offset:2048
    v_mfma_f32_16x16x32_bf16 v[56:59], v[192:195], v[160:163], v[56:59]
    ds_read_b128 v[144:147], v13 offset:4096
    v_mfma_f32_16x16x32_bf16 v[60:63], v[192:195], v[164:167], v[60:63]
    buffer_load_dwordx4 v[36:39], v22, s[28:31], s48 offen offset:1024 sc1
    ds_read_b128 v[148:151], v13 offset:6144
    v_mfma_f32_16x16x32_bf16 v[112:115], v[192:195], v[172:175], v[112:115]
    buffer_load_dwordx4 v[40:43], v22, s[28:31], s48 offen offset:1536 sc1
    s_mov_b64 exec, s[84:85]
    ds_read_b128 v[168:171], v15
    s_mov_b64 exec, -1
    v_mfma_f32_16x16x32_bf16 v[64:67], v[196:199], v[152:155], v[64:67]
    v_mfma_f32_16x16x32_bf16 v[68:71], v[196:199], v[156:159], v[68:71]
    buffer_load_dwordx4 v[44:47], v22, s[28:31], s49 offen sc1
    v_mfma_f32_16x16x32_bf16 v[72:75], v[196:199], v[160:163], v[72:75]
    ds_read_b64_tr_b16 v[176:177], v17 offset:0
    v_mfma_f32_16x16x32_bf16 v[76:79], v[196:199], v[164:167], v[76:79]
    s_mul_i32 s68, s91, 5120
    ds_read_b64_tr_b16 v[178:179], v17 offset:3840
    v_mfma_f32_16x16x32_bf16 v[116:119], v[196:199], v[172:175], v[116:119]
    s_add_u32 s68, s68, 4096
    ds_read_b64_tr_b16 v[180:181], v18 offset:0
    s_setprio 2
    v_mfma_f32_16x16x32_bf16 v[80:83], v[200:203], v[152:155], v[80:83]
    ds_read_b64_tr_b16 v[182:183], v18 offset:3840
    v_mfma_f32_16x16x32_bf16 v[84:87], v[200:203], v[156:159], v[84:87]
    buffer_load_dwordx4 v[232:235], v9, s[24:27], s68 offen sc1
    ds_read_b64_tr_b16 v[184:185], v19 offset:0
    v_mfma_f32_16x16x32_bf16 v[88:91], v[200:203], v[160:163], v[88:91]
    s_mul_i32 s68, s92, 5120
    ds_read_b64_tr_b16 v[186:187], v19 offset:3840
    v_mfma_f32_16x16x32_bf16 v[92:95], v[200:203], v[164:167], v[92:95]
    ds_read_b64_tr_b16 v[188:189], v20 offset:0
    v_mfma_f32_16x16x32_bf16 v[96:99], v[204:207], v[152:155], v[96:99]
    buffer_load_dwordx4 v[236:239], v9, s[24:27], s68 offen offset:0 sc1
    ds_read_b64_tr_b16 v[190:191], v20 offset:3840
    v_mfma_f32_16x16x32_bf16 v[100:103], v[204:207], v[156:159], v[100:103]
    v_mfma_f32_16x16x32_bf16 v[104:107], v[204:207], v[160:163], v[104:107]
    v_mfma_f32_16x16x32_bf16 v[108:111], v[204:207], v[164:167], v[108:111]
    s_add_u32 s65, s65, 1
    s_waitcnt lgkmcnt(0)
    v_mfma_f32_16x16x32_bf16 v[48:51], v[176:179], v[136:139], v[48:51]
    s_setprio 1
    ds_read_b128 v[152:155], v14 offset:0
    v_mfma_f32_16x16x32_bf16 v[52:55], v[176:179], v[140:143], v[52:55]
    ds_read_b128 v[156:159], v14 offset:2048
    v_mfma_f32_16x16x32_bf16 v[56:59], v[176:179], v[144:147], v[56:59]
    s_mul_i32 s68, s92, 5120
    ds_read_b128 v[160:163], v14 offset:4096
    v_mfma_f32_16x16x32_bf16 v[60:63], v[176:179], v[148:151], v[60:63]
    ds_read_b128 v[164:167], v14 offset:6144
    v_mfma_f32_16x16x32_bf16 v[112:115], v[176:179], v[168:171], v[112:115]
    s_mov_b64 exec, s[84:85]
    ds_read_b128 v[172:175], v16
    s_mov_b64 exec, -1
    v_mfma_f32_16x16x32_bf16 v[64:67], v[180:183], v[136:139], v[64:67]
    buffer_load_dwordx4 v[240:243], v9, s[24:27], s68 offen offset:1024 sc1
    v_mfma_f32_16x16x32_bf16 v[68:71], v[180:183], v[140:143], v[68:71]
    v_mfma_f32_16x16x32_bf16 v[72:75], v[180:183], v[144:147], v[72:75]
    ds_read_b64_tr_b16 v[192:193], v17 offset:15360
    v_mfma_f32_16x16x32_bf16 v[76:79], v[180:183], v[148:151], v[76:79]
    ds_read_b64_tr_b16 v[194:195], v17 offset:19200
    v_mfma_f32_16x16x32_bf16 v[116:119], v[180:183], v[168:171], v[116:119]
    s_setprio 0
    s_mul_i32 s68, s92, 5120
    ds_read_b64_tr_b16 v[196:197], v18 offset:15360
    v_mfma_f32_16x16x32_bf16 v[80:83], v[184:187], v[136:139], v[80:83]
    ds_read_b64_tr_b16 v[198:199], v18 offset:19200
    v_mfma_f32_16x16x32_bf16 v[84:87], v[184:187], v[140:143], v[84:87]
    ds_read_b64_tr_b16 v[200:201], v19 offset:15360
    v_mfma_f32_16x16x32_bf16 v[88:91], v[184:187], v[144:147], v[88:91]
    ds_read_b64_tr_b16 v[202:203], v19 offset:19200
    v_mfma_f32_16x16x32_bf16 v[92:95], v[184:187], v[148:151], v[92:95]
    buffer_load_dwordx4 v[244:247], v9, s[24:27], s68 offen offset:2048 sc1
    ds_read_b64_tr_b16 v[204:205], v20 offset:15360
    v_mfma_f32_16x16x32_bf16 v[96:99], v[188:191], v[136:139], v[96:99]
    ds_read_b64_tr_b16 v[206:207], v20 offset:19200
    v_mfma_f32_16x16x32_bf16 v[100:103], v[188:191], v[140:143], v[100:103]
    v_mfma_f32_16x16x32_bf16 v[104:107], v[188:191], v[144:147], v[104:107]
    v_mfma_f32_16x16x32_bf16 v[108:111], v[188:191], v[148:151], v[108:111]
    s_waitcnt lgkmcnt(0)
    s_barrier
    s_setprio 3
    v_mfma_f32_16x16x32_bf16 v[48:51], v[192:195], v[152:155], v[48:51]
    s_mul_i32 s68, s92, 5120
    buffer_load_dwordx4 v[248:251], v9, s[24:27], s68 offen offset:3072 sc1
    s_mul_i32 s68, s92, 5120
    s_add_u32 s68, s68, 4096
    buffer_load_dwordx4 v[252:255], v9, s[24:27], s68 offen sc1
    v_mfma_f32_16x16x32_bf16 v[52:55], v[192:195], v[156:159], v[52:55]
    s_lshl_b32 s76, s77, 6
    s_add_u32 s76, s76, 16
    s_mul_i32 s76, s76, 592
    v_mul_u32_u24 v6, 592, v3
    v_lshlrev_b32 v7, 4, v2
    v_mfma_f32_16x16x32_bf16 v[56:59], v[192:195], v[160:163], v[56:59]
    s_lshl_b32 s73, s78, 6
    s_add_u32 s73, s73, 88064
    v_add_u32 v11, s73, v7
    s_mul_i32 s73, s78, 52
    s_lshr_b32 s73, s73, 8
    v_mfma_f32_16x16x32_bf16 v[60:63], v[192:195], v[164:167], v[60:63]
    s_mul_i32 s75, s73, 5
    s_sub_u32 s75, s78, s75
    s_lshl_b32 s75, s75, 2
    s_mul_i32 s73, s73, 192
    v_mfma_f32_16x16x32_bf16 v[112:115], v[192:195], v[172:175], v[112:115]
    v_add_u32 v4, s75, v2
    v_mul_u32_u24 v5, 52, v4
    v_lshrrev_b32 v5, 8, v5
    v_add_u32 v4, v4, v5
    v_lshl_add_u32 v4, v4, 3, v6
    v_mfma_f32_16x16x32_bf16 v[64:67], v[196:199], v[152:155], v[64:67]
    v_add_u32 v19, s73, v4
    s_add_u32 s73, s73, s76
    v_add_u32 v15, s73, v4
    s_lshl_b32 s73, s79, 6
    s_add_u32 s73, s73, 88064
    v_mfma_f32_16x16x32_bf16 v[68:71], v[196:199], v[156:159], v[68:71]
    v_add_u32 v12, s73, v7
    s_mul_i32 s73, s79, 52
    s_lshr_b32 s73, s73, 8
    s_mul_i32 s75, s73, 5
    s_sub_u32 s75, s79, s75
    v_mfma_f32_16x16x32_bf16 v[72:75], v[196:199], v[160:163], v[72:75]
    s_lshl_b32 s75, s75, 2
    s_mul_i32 s73, s73, 192
    v_add_u32 v4, s75, v2
    v_mul_u32_u24 v5, 52, v4
    v_mfma_f32_16x16x32_bf16 v[76:79], v[196:199], v[164:167], v[76:79]
    v_lshrrev_b32 v5, 8, v5
    v_add_u32 v4, v4, v5
    v_lshl_add_u32 v4, v4, 3, v6
    v_add_u32 v20, s73, v4
    s_add_u32 s73, s73, s76
    v_mfma_f32_16x16x32_bf16 v[116:119], v[196:199], v[172:175], v[116:119]
    v_add_u32 v16, s73, v4
    s_lshl_b32 s73, s80, 6
    s_add_u32 s73, s73, 88064
    v_add_u32 v13, s73, v7
    s_mul_i32 s73, s80, 52
    s_setprio 2
    v_mfma_f32_16x16x32_bf16 v[80:83], v[200:203], v[152:155], v[80:83]
    s_lshr_b32 s73, s73, 8
    s_mul_i32 s75, s73, 5
    s_sub_u32 s75, s80, s75
    s_lshl_b32 s75, s75, 2
    s_mul_i32 s73, s73, 192
    v_mfma_f32_16x16x32_bf16 v[84:87], v[200:203], v[156:159], v[84:87]
    v_add_u32 v4, s75, v2
    v_mul_u32_u24 v5, 52, v4
    v_lshrrev_b32 v5, 8, v5
    v_add_u32 v4, v4, v5
    v_mfma_f32_16x16x32_bf16 v[88:91], v[200:203], v[160:163], v[88:91]
    v_lshl_add_u32 v4, v4, 3, v6
    s_add_u32 s73, s73, s76
    v_add_u32 v17, s73, v4
    s_lshl_b32 s73, s81, 6
    s_add_u32 s73, s73, 88064
    v_mfma_f32_16x16x32_bf16 v[92:95], v[200:203], v[164:167], v[92:95]
    v_add_u32 v14, s73, v7
    s_mul_i32 s73, s81, 52
    s_lshr_b32 s73, s73, 8
    s_mul_i32 s75, s73, 5
    s_sub_u32 s75, s81, s75
    v_mfma_f32_16x16x32_bf16 v[96:99], v[204:207], v[152:155], v[96:99]
    s_lshl_b32 s75, s75, 2
    s_mul_i32 s73, s73, 192
    v_add_u32 v4, s75, v2
    v_mul_u32_u24 v5, 52, v4
    v_lshrrev_b32 v5, 8, v5
    v_mfma_f32_16x16x32_bf16 v[100:103], v[204:207], v[156:159], v[100:103]
    v_add_u32 v4, v4, v5
    v_lshl_add_u32 v4, v4, 3, v6
    s_add_u32 s73, s73, s76
    v_add_u32 v18, s73, v4
    v_mfma_f32_16x16x32_bf16 v[104:107], v[204:207], v[160:163], v[104:107]
    v_mfma_f32_16x16x32_bf16 v[108:111], v[204:207], v[164:167], v[108:111]
    s_setprio 0
    s_not_b64 exec, s[84:85]
    ds_write_b128 v11, v[112:115]
    ds_write_b128 v12, v[116:119]
    s_mov_b64 exec, -1
    s_waitcnt vmcnt(6)
    s_mov_b32 s98, 0
    s_branch Lpo_29
Lpo_27:
    buffer_load_dwordx4 v[28:31], v22, s[28:31], s48 offen offset:0 sc1
    buffer_load_dwordx4 v[32:35], v22, s[28:31], s48 offen offset:512 sc1
    buffer_load_dwordx4 v[36:39], v22, s[28:31], s48 offen offset:1024 sc1
    buffer_load_dwordx4 v[40:43], v22, s[28:31], s48 offen offset:1536 sc1
    buffer_load_dwordx4 v[44:47], v22, s[28:31], s49 offen sc1
    s_waitcnt vmcnt(0)
Lpo_29:
    v_cmp_eq_u64 vcc, s[82:83], v[30:31]
    v_cmp_eq_u64 s[74:75], s[82:83], v[34:35]
    s_nop 0
    s_and_b64 vcc, vcc, s[74:75]
    v_cmp_eq_u64 s[74:75], s[82:83], v[38:39]
    s_nop 0
    s_and_b64 vcc, vcc, s[74:75]
    v_cmp_eq_u64 s[74:75], s[82:83], v[42:43]
    s_nop 0
    s_and_b64 vcc, vcc, s[74:75]
    v_cmp_eq_u64 s[74:75], s[82:83], v[46:47]
    s_nop 0
    s_and_b64 vcc, vcc, s[74:75]
    s_add_u32 s98, s98, 1
    s_cmp_gt_u32 s98, 100000
    s_cbranch_scc1 Lpo_28
    s_cmp_eq_u64 vcc, -1
    s_cbranch_scc0 Lpo_27
Lpo_28:
    s_waitcnt lgkmcnt(0)
    s_barrier
    ds_read_b128 v[120:123], v11
    ds_read_b128 v[124:127], v12
    ds_read_b128 v[128:131], v13
    ds_read_b128 v[132:135], v14
    s_waitcnt lgkmcnt(3)
    v_pk_mul_f32 v[24:25], v[120:121], v[28:29] op_sel:[0,1] op_sel_hi:[1,1]
    v_pk_mul_f32 v[26:27], v[122:123], v[28:29] op_sel:[0,1] op_sel_hi:[1,1]
    v_pk_fma_f32 v[48:49], v[48:49], v[28:29], v[24:25] op_sel:[0,0,0] op_sel_hi:[1,0,1]
    v_pk_fma_f32 v[50:51], v[50:51], v[28:29], v[26:27] op_sel:[0,0,0] op_sel_hi:[1,0,1]
    v_cvt_pk_bf16_f32 v48, v48, v49
    v_cvt_pk_bf16_f32 v49, v50, v51
    ds_write_b64 v15, v[48:49] offset:0
    v_pk_mul_f32 v[24:25], v[120:121], v[32:33] op_sel:[0,1] op_sel_hi:[1,1]
    v_pk_mul_f32 v[26:27], v[122:123], v[32:33] op_sel:[0,1] op_sel_hi:[1,1]
    v_pk_fma_f32 v[52:53], v[52:53], v[32:33], v[24:25] op_sel:[0,0,0] op_sel_hi:[1,0,1]
    v_pk_fma_f32 v[54:55], v[54:55], v[32:33], v[26:27] op_sel:[0,0,0] op_sel_hi:[1,0,1]
    v_cvt_pk_bf16_f32 v52, v52, v53
    v_cvt_pk_bf16_f32 v53, v54, v55
    ds_write_b64 v15, v[52:53] offset:9472
    v_pk_mul_f32 v[24:25], v[120:121], v[36:37] op_sel:[0,1] op_sel_hi:[1,1]
    s_mul_i32 s68, s88, 5120
    buffer_load_dwordx4 v[156:159], v9, s[24:27], s68 offen offset:0 sc1
    v_pk_mul_f32 v[26:27], v[122:123], v[36:37] op_sel:[0,1] op_sel_hi:[1,1]
    v_pk_fma_f32 v[56:57], v[56:57], v[36:37], v[24:25] op_sel:[0,0,0] op_sel_hi:[1,0,1]
    v_pk_fma_f32 v[58:59], v[58:59], v[36:37], v[26:27] op_sel:[0,0,0] op_sel_hi:[1,0,1]
    v_cvt_pk_bf16_f32 v56, v56, v57
    v_cvt_pk_bf16_f32 v57, v58, v59
    ds_write_b64 v15, v[56:57] offset:18944
    v_pk_mul_f32 v[24:25], v[120:121], v[40:41] op_sel:[0,1] op_sel_hi:[1,1]
    v_pk_mul_f32 v[26:27], v[122:123], v[40:41] op_sel:[0,1] op_sel_hi:[1,1]
    v_pk_fma_f32 v[60:61], v[60:61], v[40:41], v[24:25] op_sel:[0,0,0] op_sel_hi:[1,0,1]
    v_pk_fma_f32 v[62:63], v[62:63], v[40:41], v[26:27] op_sel:[0,0,0] op_sel_hi:[1,0,1]
    v_cvt_pk_bf16_f32 v60, v60, v61
    v_cvt_pk_bf16_f32 v61, v62, v63
    ds_write_b64 v15, v[60:61] offset:28416
    v_pk_mul_f32 v[24:25], v[120:121], v[44:45] op_sel:[0,1] op_sel_hi:[1,1]
    v_pk_mul_f32 v[26:27], v[122:123], v[44:45] op_sel:[0,1] op_sel_hi:[1,1]
    v_pk_fma_f32 v[112:113], v[112:113], v[44:45], v[24:25] op_sel:[0,0,0] op_sel_hi:[1,0,1]
    s_mul_i32 s68, s88, 5120
    buffer_load_dwordx4 v[160:163], v9, s[24:27], s68 offen offset:1024 sc1
    v_pk_fma_f32 v[114:115], v[114:115], v[44:45], v[26:27] op_sel:[0,0,0] op_sel_hi:[1,0,1]
    v_cvt_pk_bf16_f32 v112, v112, v113
    v_cvt_pk_bf16_f32 v113, v114, v115
    ds_write_b64 v19, v[112:113] offset:0
    s_nop 0
    s_waitcnt lgkmcnt(5)
    v_pk_mul_f32 v[24:25], v[124:125], v[28:29] op_sel:[0,1] op_sel_hi:[1,1]
    v_pk_mul_f32 v[26:27], v[126:127], v[28:29] op_sel:[0,1] op_sel_hi:[1,1]
    v_pk_fma_f32 v[64:65], v[64:65], v[28:29], v[24:25] op_sel:[0,0,0] op_sel_hi:[1,0,1]
    v_pk_fma_f32 v[66:67], v[66:67], v[28:29], v[26:27] op_sel:[0,0,0] op_sel_hi:[1,0,1]
    v_cvt_pk_bf16_f32 v64, v64, v65
    v_cvt_pk_bf16_f32 v65, v66, v67
    ds_write_b64 v16, v[64:65] offset:0
    v_pk_mul_f32 v[24:25], v[124:125], v[32:33] op_sel:[0,1] op_sel_hi:[1,1]
    v_pk_mul_f32 v[26:27], v[126:127], v[32:33] op_sel:[0,1] op_sel_hi:[1,1]
    v_pk_fma_f32 v[68:69], v[68:69], v[32:33], v[24:25] op_sel:[0,0,0] op_sel_hi:[1,0,1]
    s_mul_i32 s68, s88, 5120
    buffer_load_dwordx4 v[164:167], v9, s[24:27], s68 offen offset:2048 sc1
    v_pk_fma_f32 v[70:71], v[70:71], v[32:33], v[26:27] op_sel:[0,0,0] op_sel_hi:[1,0,1]
    v_cvt_pk_bf16_f32 v68, v68, v69
    v_cvt_pk_bf16_f32 v69, v70, v71
    ds_write_b64 v16, v[68:69] offset:9472
    v_pk_mul_f32 v[24:25], v[124:125], v[36:37] op_sel:[0,1] op_sel_hi:[1,1]
    v_pk_mul_f32 v[26:27], v[126:127], v[36:37] op_sel:[0,1] op_sel_hi:[1,1]
    v_pk_fma_f32 v[72:73], v[72:73], v[36:37], v[24:25] op_sel:[0,0,0] op_sel_hi:[1,0,1]
    v_pk_fma_f32 v[74:75], v[74:75], v[36:37], v[26:27] op_sel:[0,0,0] op_sel_hi:[1,0,1]
    v_cvt_pk_bf16_f32 v72, v72, v73
    v_cvt_pk_bf16_f32 v73, v74, v75
    ds_write_b64 v16, v[72:73] offset:18944
    v_pk_mul_f32 v[24:25], v[124:125], v[40:41] op_sel:[0,1] op_sel_hi:[1,1]
    v_pk_mul_f32 v[26:27], v[126:127], v[40:41] op_sel:[0,1] op_sel_hi:[1,1]
    v_pk_fma_f32 v[76:77], v[76:77], v[40:41], v[24:25] op_sel:[0,0,0] op_sel_hi:[1,0,1]
    v_pk_fma_f32 v[78:79], v[78:79], v[40:41], v[26:27] op_sel:[0,0,0] op_sel_hi:[1,0,1]
    v_cvt_pk_bf16_f32 v76, v76, v77
    s_mul_i32 s68, s88, 5120
    buffer_load_dwordx4 v[168:171], v9, s[24:27], s68 offen offset:3072 sc1
    v_cvt_pk_bf16_f32 v77, v78, v79
    ds_write_b64 v16, v[76:77] offset:28416
    v_pk_mul_f32 v[24:25], v[124:125], v[44:45] op_sel:[0,1] op_sel_hi:[1,1]
    v_pk_mul_f32 v[26:27], v[126:127], v[44:45] op_sel:[0,1] op_sel_hi:[1,1]
    v_pk_fma_f32 v[116:117], v[116:117], v[44:45], v[24:25] op_sel:[0,0,0] op_sel_hi:[1,0,1]
    v_pk_fma_f32 v[118:119], v[118:119], v[44:45], v[26:27] op_sel:[0,0,0] op_sel_hi:[1,0,1]
    v_cvt_pk_bf16_f32 v116, v116, v117
    v_cvt_pk_bf16_f32 v117, v118, v119
    ds_write_b64 v20, v[116:117] offset:0
    s_nop 0
    v_pk_mul_f32 v[24:25], v[128:129], v[28:29] op_sel:[0,1] op_sel_hi:[1,1]
    v_pk_mul_f32 v[26:27], v[130:131], v[28:29] op_sel:[0,1] op_sel_hi:[1,1]
    v_pk_fma_f32 v[80:81], v[80:81], v[28:29], v[24:25] op_sel:[0,0,0] op_sel_hi:[1,0,1]
    v_pk_fma_f32 v[82:83], v[82:83], v[28:29], v[26:27] op_sel:[0,0,0] op_sel_hi:[1,0,1]
    v_cvt_pk_bf16_f32 v80, v80, v81
    v_cvt_pk_bf16_f32 v81, v82, v83
    s_mul_i32 s68, s88, 5120
    s_add_u32 s68, s68, 4096
    buffer_load_dwordx4 v[172:175], v9, s[24:27], s68 offen sc1
    ds_write_b64 v17, v[80:81] offset:0
    v_pk_mul_f32 v[24:25], v[128:129], v[32:33] op_sel:[0,1] op_sel_hi:[1,1]
    v_pk_mul_f32 v[26:27], v[130:131], v[32:33] op_sel:[0,1] op_sel_hi:[1,1]
    v_pk_fma_f32 v[84:85], v[84:85], v[32:33], v[24:25] op_sel:[0,0,0] op_sel_hi:[1,0,1]
    v_pk_fma_f32 v[86:87], v[86:87], v[32:33], v[26:27] op_sel:[0,0,0] op_sel_hi:[1,0,1]
    v_cvt_pk_bf16_f32 v84, v84, v85
    v_cvt_pk_bf16_f32 v85, v86, v87
    ds_write_b64 v17, v[84:85] offset:9472
    v_pk_mul_f32 v[24:25], v[128:129], v[36:37] op_sel:[0,1] op_sel_hi:[1,1]
    v_pk_mul_f32 v[26:27], v[130:131], v[36:37] op_sel:[0,1] op_sel_hi:[1,1]
    v_pk_fma_f32 v[88:89], v[88:89], v[36:37], v[24:25] op_sel:[0,0,0] op_sel_hi:[1,0,1]
    v_pk_fma_f32 v[90:91], v[90:91], v[36:37], v[26:27] op_sel:[0,0,0] op_sel_hi:[1,0,1]
    v_cvt_pk_bf16_f32 v88, v88, v89
    v_cvt_pk_bf16_f32 v89, v90, v91
    ds_write_b64 v17, v[88:89] offset:18944
    v_pk_mul_f32 v[24:25], v[128:129], v[40:41] op_sel:[0,1] op_sel_hi:[1,1]
    s_mul_i32 s68, s89, 5120
    buffer_load_dwordx4 v[176:179], v9, s[24:27], s68 offen offset:0 sc1
    v_pk_mul_f32 v[26:27], v[130:131], v[40:41] op_sel:[0,1] op_sel_hi:[1,1]
    v_pk_fma_f32 v[92:93], v[92:93], v[40:41], v[24:25] op_sel:[0,0,0] op_sel_hi:[1,0,1]
    v_pk_fma_f32 v[94:95], v[94:95], v[40:41], v[26:27] op_sel:[0,0,0] op_sel_hi:[1,0,1]
    v_cvt_pk_bf16_f32 v92, v92, v93
    v_cvt_pk_bf16_f32 v93, v94, v95
    ds_write_b64 v17, v[92:93] offset:28416
    s_nop 0
    v_pk_mul_f32 v[24:25], v[132:133], v[28:29] op_sel:[0,1] op_sel_hi:[1,1]
    v_pk_mul_f32 v[26:27], v[134:135], v[28:29] op_sel:[0,1] op_sel_hi:[1,1]
    v_pk_fma_f32 v[96:97], v[96:97], v[28:29], v[24:25] op_sel:[0,0,0] op_sel_hi:[1,0,1]
    v_pk_fma_f32 v[98:99], v[98:99], v[28:29], v[26:27] op_sel:[0,0,0] op_sel_hi:[1,0,1]
    v_cvt_pk_bf16_f32 v96, v96, v97
    v_cvt_pk_bf16_f32 v97, v98, v99
    ds_write_b64 v18, v[96:97] offset:0
    v_pk_mul_f32 v[24:25], v[132:133], v[32:33] op_sel:[0,1] op_sel_hi:[1,1]
    v_pk_mul_f32 v[26:27], v[134:135], v[32:33] op_sel:[0,1] op_sel_hi:[1,1]
    s_mul_i32 s68, s89, 5120
    buffer_load_dwordx4 v[180:183], v9, s[24:27], s68 offen offset:1024 sc1
    v_pk_fma_f32 v[100:101], v[100:101], v[32:33], v[24:25] op_sel:[0,0,0] op_sel_hi:[1,0,1]
    v_pk_fma_f32 v[102:103], v[102:103], v[32:33], v[26:27] op_sel:[0,0,0] op_sel_hi:[1,0,1]
    v_cvt_pk_bf16_f32 v100, v100, v101
    v_cvt_pk_bf16_f32 v101, v102, v103
    ds_write_b64 v18, v[100:101] offset:9472
    v_pk_mul_f32 v[24:25], v[132:133], v[36:37] op_sel:[0,1] op_sel_hi:[1,1]
    v_pk_mul_f32 v[26:27], v[134:135], v[36:37] op_sel:[0,1] op_sel_hi:[1,1]
    v_pk_fma_f32 v[104:105], v[104:105], v[36:37], v[24:25] op_sel:[0,0,0] op_sel_hi:[1,0,1]
    v_pk_fma_f32 v[106:107], v[106:107], v[36:37], v[26:27] op_sel:[0,0,0] op_sel_hi:[1,0,1]
    v_cvt_pk_bf16_f32 v104, v104, v105
    v_cvt_pk_bf16_f32 v105, v106, v107
    ds_write_b64 v18, v[104:105] offset:18944
    v_pk_mul_f32 v[24:25], v[132:133], v[40:41] op_sel:[0,1] op_sel_hi:[1,1]
    v_pk_mul_f32 v[26:27], v[134:135], v[40:41] op_sel:[0,1] op_sel_hi:[1,1]
    v_pk_fma_f32 v[108:109], v[108:109], v[40:41], v[24:25] op_sel:[0,0,0] op_sel_hi:[1,0,1]
    v_pk_fma_f32 v[110:111], v[110:111], v[40:41], v[26:27] op_sel:[0,0,0] op_sel_hi:[1,0,1]
    s_mul_i32 s68, s89, 5120
    buffer_load_dwordx4 v[184:187], v9, s[24:27], s68 offen offset:2048 sc1
    v_cvt_pk_bf16_f32 v108, v108, v109
    v_cvt_pk_bf16_f32 v109, v110, v111
    ds_write_b64 v18, v[108:109] offset:28416
    s_and_b32 s73, s62, 1
    s_lshr_b32 s76, s62, 1
    s_lshl_b32 s75, s76, 5
    s_add_u32 s75, s75, 2
    s_mul_i32 s75, s75, 592
    s_mul_i32 s74, s73, 96
    s_add_u32 s75, s75, s74
    v_lshl_add_u32 v4, v2, 4, s75
    v_mul_u32_u24 v5, 1184, v3
    v_add_u32 v11, v4, v5
    v_min_u32 v5, 6, v3
    v_mul_u32_u24 v5, 1184, v5
    v_add3_u32 v12, v4, v5, 0
    s_mul_i32 s68, s89, 5120
    buffer_load_dwordx4 v[188:191], v9, s[24:27], s68 offen offset:3072 sc1
    v_and_b32 v4, 3, v1
    v_lshl_add_u32 v4, v4, 3, s75
    v_lshrrev_b32 v6, 2, v1
    v_mul_u32_u24 v5, 1184, v6
    v_add_u32 v13, v4, v5
    v_min_u32 v5, 6, v6
    v_mul_u32_u24 v5, 1184, v5
    v_add_u32 v14, v4, v5
    s_lshl_b32 s75, s64, 1
    s_add_u32 s75, s75, s73
    s_lshl_b32 s73, s63, 1
    s_add_u32 s73, s73, s77
    s_mul_i32 s73, s73, 303104
    s_and_b32 s74, s76, 1
    s_lshl_b32 s74, s74, 11
    s_add_u32 s73, s73, s74
    s_mul_i32 s68, s89, 5120
    s_add_u32 s68, s68, 4096
    buffer_load_dwordx4 v[192:195], v9, s[24:27], s68 offen sc1
    s_lshr_b32 s74, s75, 3
    s_lshl_b32 s66, s74, 1
    s_add_u32 s66, s66, s75
    s_lshl_b32 s66, s66, 12
    s_add_u32 s66, s66, s73
    s_mul_i32 s67, s74, 10
    s_bfe_u32 s74, s75, 0x10002
    s_add_u32 s67, s67, s74
    s_add_u32 s67, s67, 8
    s_lshl_b32 s67, s67, 12
    s_add_u32 s67, s67, s73
    s_and_b32 s74, s75, 3
    s_lshl_b32 s74, s74, 8
    s_add_u32 s67, s67, s74
    s_waitcnt lgkmcnt(0)
    s_barrier
    ds_read_b128 v[30:33], v11 offset:8288
    ds_read_b128 v[34:37], v11 offset:192
    ds_read_b128 v[38:41], v12 offset:19136
    ds_read_b128 v[42:45], v11 offset:8336
    ds_read_b128 v[46:49], v11 offset:240
    ds_read_b128 v[50:53], v12 offset:19184
    ds_read_b128 v[54:57], v11 offset:8880
    ds_read_b128 v[58:61], v11 offset:784
    ds_read_b128 v[62:65], v12 offset:19728
    ds_read_b128 v[66:69], v11 offset:8928
    ds_read_b128 v[70:73], v11 offset:832
    ds_read_b128 v[74:77], v12 offset:19776
    v_cmp_gt_u32 vcc, 3, v2
    v_cmp_gt_u32 s[74:75], 2, v2
    v_lshlrev_b32 v4, 2, v2
    v_sub_u32 v5, v4, v3
    v_cndmask_b32 v16, 0, -1, vcc
    v_cndmask_b32 v17, 0, -1, s[74:75]
    v_mov_b32 v7, 0xf149f2ca
    v_add_u32 v18, 0, v5
    v_add_u32 v19, 1, v5
    v_add_u32 v20, 2, v5
    v_add_u32 v21, 3, v5
    v_add_u32 v22, 16, v5
    v_add_u32 v23, 17, v5
    v_add_u32 v24, 18, v5
    v_add_u32 v25, 19, v5
    v_cmp_gt_u32 vcc, 8, v18
    v_cmp_gt_u32 s[74:75], 8, v19
    v_mov_b32 v26, 0x3f803f80
    s_mul_i32 s68, s90, 5120
    buffer_load_dwordx4 v[196:199], v9, s[24:27], s68 offen offset:0 sc1
    v_cndmask_b32 v18, v7, 0, vcc
    v_cndmask_b32 v19, v7, 0, s[74:75]
    v_cmp_gt_u32 vcc, 8, v20
    v_cmp_gt_u32 s[74:75], 8, v21
    v_mov_b32 v27, 0x3f803f80
    v_cndmask_b32 v20, v7, 0, vcc
    v_cndmask_b32 v21, v7, 0, s[74:75]
    v_cmp_gt_u32 vcc, 8, v22
    v_cmp_gt_u32 s[74:75], 8, v23
    v_mov_b32 v28, 0x3f803f80
    v_cndmask_b32 v22, v7, 0, vcc
    v_cndmask_b32 v23, v7, 0, s[74:75]
    v_cmp_gt_u32 vcc, 8, v24
    v_cmp_gt_u32 s[74:75], 8, v25
    v_mov_b32 v29, 0x3f803f80
    v_cndmask_b32 v24, v7, 0, vcc
    v_cndmask_b32 v25, v7, 0, s[74:75]
    s_or_b32 s75, s63, s76
    s_cmp_lg_u32 s75, 0
    s_cbranch_scc1 Lm_30
    v_cmp_le_u32 vcc, 7, v4
    s_nop 1
    v_cndmask_b32 v18, v7, v18, vcc
    v_cmp_le_u32 vcc, 6, v4
    s_nop 1
    v_cndmask_b32 v19, v7, v19, vcc
    v_cmp_le_u32 vcc, 5, v4
    s_nop 1
    v_cndmask_b32 v20, v7, v20, vcc
    v_cmp_le_u32 vcc, 4, v4
    s_nop 1
    v_cndmask_b32 v21, v7, v21, vcc
Lm_30:
    s_waitcnt lgkmcnt(11)
    v_and_b32 v30, v16, v30
    v_and_b32 v31, v16, v31
    v_and_b32 v32, v17, v32
    v_and_b32 v33, v17, v33
    s_waitcnt lgkmcnt(8)
    v_and_b32 v42, v16, v42
    s_mul_i32 s68, s90, 5120
    buffer_load_dwordx4 v[200:203], v9, s[24:27], s68 offen offset:1024 sc1
    v_and_b32 v43, v16, v43
    v_and_b32 v44, v17, v44
    v_and_b32 v45, v17, v45
    s_waitcnt lgkmcnt(5)
    v_and_b32 v54, v16, v54
    v_and_b32 v55, v16, v55
    v_and_b32 v56, v17, v56
    v_and_b32 v57, v17, v57
    s_waitcnt lgkmcnt(2)
    v_and_b32 v66, v16, v66
    v_and_b32 v67, v16, v67
    v_and_b32 v68, v17, v68
    v_and_b32 v69, v17, v69
    s_waitcnt lgkmcnt(0)
    v_mfma_f32_16x16x32_bf16 v[78:81], v[34:37], v[30:33], v[18:21]
    v_mfma_f32_16x16x32_bf16 v[82:85], v[38:41], v[30:33], v[22:25]
    v_mfma_f32_16x16x32_bf16 v[86:89], v[46:49], v[42:45], v[18:21]
    v_mfma_f32_16x16x32_bf16 v[90:93], v[50:53], v[42:45], v[22:25]
    v_mfma_f32_16x16x32_bf16 v[94:97], v[58:61], v[54:57], v[18:21]
    v_mfma_f32_16x16x32_bf16 v[98:101], v[62:65], v[54:57], v[22:25]
    v_mfma_f32_16x16x32_bf16 v[102:105], v[70:73], v[66:69], v[18:21]
    v_mfma_f32_16x16x32_bf16 v[106:109], v[74:77], v[66:69], v[22:25]
    ds_read_b64_tr_b16 v[110:111], v13 offset:384
    ds_read_b64_tr_b16 v[112:113], v14 offset:19328
    s_mul_i32 s68, s90, 5120
    buffer_load_dwordx4 v[204:207], v9, s[24:27], s68 offen offset:2048 sc1
    ds_read_b64_tr_b16 v[114:115], v13 offset:416
    ds_read_b64_tr_b16 v[116:117], v14 offset:19360
    ds_read_b64_tr_b16 v[118:119], v13 offset:432
    ds_read_b64_tr_b16 v[120:121], v14 offset:19376
    ds_read_b64_tr_b16 v[122:123], v13 offset:464
    ds_read_b64_tr_b16 v[124:125], v14 offset:19408
    ds_read_b64_tr_b16 v[126:127], v13 offset:976
    ds_read_b64_tr_b16 v[128:129], v14 offset:19920
    ds_read_b64_tr_b16 v[130:131], v13 offset:1008
    ds_read_b64_tr_b16 v[132:133], v14 offset:19952
    ds_read_b64_tr_b16 v[134:135], v13 offset:1024
    ds_read_b64_tr_b16 v[136:137], v14 offset:19968
    ds_read_b64_tr_b16 v[138:139], v13 offset:1056
    ds_read_b64_tr_b16 v[140:141], v14 offset:20000
    s_mov_b32 s73, 0x3ea52b5c
    v_max3_f32 v142, v78, v79, v80
    v_max3_f32 v144, v86, v87, v88
    v_max3_f32 v146, v94, v95, v96
    v_max3_f32 v148, v102, v103, v104
    v_max3_f32 v143, v81, v82, v83
    v_max3_f32 v145, v89, v90, v91
    v_max3_f32 v147, v97, v98, v99
    v_max3_f32 v149, v105, v106, v107
    v_max3_f32 v142, v142, v84, v85
    v_max3_f32 v144, v144, v92, v93
    s_mul_i32 s68, s90, 5120
    buffer_load_dwordx4 v[208:211], v9, s[24:27], s68 offen offset:3072 sc1
    v_max3_f32 v146, v146, v100, v101
    v_max3_f32 v148, v148, v108, v109
    v_max_f32 v142, v142, v143
    v_max_f32 v144, v144, v145
    v_max_f32 v146, v146, v147
    v_max_f32 v148, v148, v149
    v_mov_b32 v143, v142
    v_mov_b32 v145, v144
    v_mov_b32 v147, v146
    v_mov_b32 v149, v148
    v_permlane32_swap_b32 v142, v143
    v_permlane32_swap_b32 v144, v145
    v_permlane32_swap_b32 v146, v147
    v_permlane32_swap_b32 v148, v149
    v_max_f32 v142, v142, v143
    v_max_f32 v144, v144, v145
    v_max_f32 v146, v146, v147
    v_max_f32 v148, v148, v149
    v_mov_b32 v143, v142
    v_mov_b32 v145, v144
    v_mov_b32 v147, v146
    v_mov_b32 v149, v148
    v_permlane16_swap_b32 v142, v143
    v_permlane16_swap_b32 v144, v145
    s_mul_i32 s68, s90, 5120
    s_add_u32 s68, s68, 4096
    buffer_load_dwordx4 v[212:215], v9, s[24:27], s68 offen sc1
    v_permlane16_swap_b32 v146, v147
    v_permlane16_swap_b32 v148, v149
    v_max_f32 v142, v142, v143
    v_max_f32 v144, v144, v145
    v_max_f32 v146, v146, v147
    v_max_f32 v148, v148, v149
    v_mul_f32 v142, s73, v142
    v_mul_f32 v144, s73, v144
    v_mul_f32 v146, s73, v146
    v_mul_f32 v148, s73, v148
    v_fma_f32 v78, v78, s73, -v142
    v_fma_f32 v86, v86, s73, -v144
    v_fma_f32 v94, v94, s73, -v146
    v_fma_f32 v102, v102, s73, -v148
    v_fma_f32 v79, v79, s73, -v142
    v_fma_f32 v87, v87, s73, -v144
    v_fma_f32 v95, v95, s73, -v146
    v_fma_f32 v103, v103, s73, -v148
    v_fma_f32 v80, v80, s73, -v142
    v_fma_f32 v88, v88, s73, -v144
    v_fma_f32 v96, v96, s73, -v146
    v_fma_f32 v104, v104, s73, -v148
    v_fma_f32 v81, v81, s73, -v142
    v_fma_f32 v89, v89, s73, -v144
    s_add_u32 m0, s69, 0
    s_mul_i32 s68, s93, 5120
    s_add_u32 s68, s68, 0
    buffer_load_dwordx4 v9, s[24:27], s68 offen sc1 lds
    v_fma_f32 v97, v97, s73, -v146
    v_fma_f32 v105, v105, s73, -v148
    v_fma_f32 v82, v82, s73, -v142
    v_fma_f32 v90, v90, s73, -v144
    v_fma_f32 v98, v98, s73, -v146
    v_fma_f32 v106, v106, s73, -v148
    v_fma_f32 v83, v83, s73, -v142
    v_fma_f32 v91, v91, s73, -v144
    v_fma_f32 v99, v99, s73, -v146
    v_fma_f32 v107, v107, s73, -v148
    v_fma_f32 v84, v84, s73, -v142
    v_fma_f32 v92, v92, s73, -v144
    v_fma_f32 v100, v100, s73, -v146
    v_fma_f32 v108, v108, s73, -v148
    v_fma_f32 v85, v85, s73, -v142
    v_fma_f32 v93, v93, s73, -v144
    v_fma_f32 v101, v101, s73, -v146
    v_fma_f32 v109, v109, s73, -v148
    v_exp_f32 v78, v78
    v_exp_f32 v86, v86
    v_exp_f32 v94, v94
    v_exp_f32 v102, v102
    v_exp_f32 v79, v79
    v_exp_f32 v87, v87
    s_add_u32 m0, s69, 1024
    s_mul_i32 s68, s93, 5120
    s_add_u32 s68, s68, 1024
    buffer_load_dwordx4 v9, s[24:27], s68 offen sc1 lds
    v_exp_f32 v95, v95
    v_exp_f32 v103, v103
    v_exp_f32 v80, v80
    v_exp_f32 v88, v88
    v_exp_f32 v96, v96
    v_exp_f32 v104, v104
    v_exp_f32 v81, v81
    v_exp_f32 v89, v89
    v_exp_f32 v97, v97
    v_exp_f32 v105, v105
    v_exp_f32 v82, v82
    v_exp_f32 v90, v90
    v_exp_f32 v98, v98
    v_exp_f32 v106, v106
    v_exp_f32 v83, v83
    v_exp_f32 v91, v91
    v_exp_f32 v99, v99
    v_exp_f32 v107, v107
    v_exp_f32 v84, v84
    v_exp_f32 v92, v92
    v_exp_f32 v100, v100
    v_exp_f32 v108, v108
    v_exp_f32 v85, v85
    v_exp_f32 v93, v93
    s_add_u32 m0, s69, 2048
    s_mul_i32 s68, s93, 5120
    s_add_u32 s68, s68, 2048
    buffer_load_dwordx4 v9, s[24:27], s68 offen sc1 lds
    v_exp_f32 v101, v101
    v_exp_f32 v109, v109
    v_cvt_pk_bf16_f32 v78, v78, v79
    v_cvt_pk_bf16_f32 v86, v86, v87
    v_cvt_pk_bf16_f32 v94, v94, v95
    v_cvt_pk_bf16_f32 v102, v102, v103
    v_cvt_pk_bf16_f32 v79, v80, v81
    v_cvt_pk_bf16_f32 v87, v88, v89
    v_cvt_pk_bf16_f32 v95, v96, v97
    v_cvt_pk_bf16_f32 v103, v104, v105
    v_cvt_pk_bf16_f32 v80, v82, v83
    v_cvt_pk_bf16_f32 v88, v90, v91
    v_cvt_pk_bf16_f32 v96, v98, v99
    v_cvt_pk_bf16_f32 v104, v106, v107
    v_cvt_pk_bf16_f32 v81, v84, v85
    v_cvt_pk_bf16_f32 v89, v92, v93
    v_cvt_pk_bf16_f32 v97, v100, v101
    v_cvt_pk_bf16_f32 v105, v108, v109
    s_waitcnt lgkmcnt(0)
    v_mfma_f32_16x16x32_bf16 v[38:41], v[26:29], v[78:81], 0
    v_mfma_f32_16x16x32_bf16 v[50:53], v[26:29], v[86:89], 0
    v_mfma_f32_16x16x32_bf16 v[62:65], v[26:29], v[94:97], 0
    v_mfma_f32_16x16x32_bf16 v[74:77], v[26:29], v[102:105], 0
    v_mfma_f32_16x16x32_bf16 v[30:33], v[110:113], v[78:81], 0
    s_add_u32 m0, s69, 3072
    s_mul_i32 s68, s93, 5120
    s_add_u32 s68, s68, 3072
    buffer_load_dwordx4 v9, s[24:27], s68 offen sc1 lds
    v_mfma_f32_16x16x32_bf16 v[34:37], v[114:117], v[78:81], 0
    v_mfma_f32_16x16x32_bf16 v[42:45], v[118:121], v[86:89], 0
    v_mfma_f32_16x16x32_bf16 v[46:49], v[122:125], v[86:89], 0
    v_mfma_f32_16x16x32_bf16 v[54:57], v[126:129], v[94:97], 0
    v_mfma_f32_16x16x32_bf16 v[58:61], v[130:133], v[94:97], 0
    v_mfma_f32_16x16x32_bf16 v[66:69], v[134:137], v[102:105], 0
    v_mfma_f32_16x16x32_bf16 v[70:73], v[138:141], v[102:105], 0
    v_rcp_f32 v142, v38
    v_rcp_f32 v144, v50
    v_rcp_f32 v146, v62
    v_rcp_f32 v148, v74
    s_nop 1
    v_mul_f32 v30, v30, v142
    v_mul_f32 v31, v31, v142
    v_mul_f32 v32, v32, v142
    v_mul_f32 v33, v33, v142
    v_mul_f32 v34, v34, v142
    v_mul_f32 v35, v35, v142
    v_mul_f32 v36, v36, v142
    v_mul_f32 v37, v37, v142
    v_cvt_pk_bf16_f32 v110, v30, v31
    v_cvt_pk_bf16_f32 v111, v32, v33
    v_cvt_pk_bf16_f32 v118, v34, v35
    v_cvt_pk_bf16_f32 v119, v36, v37
    v_mul_f32 v42, v42, v144
    v_mul_f32 v43, v43, v144
    v_mul_f32 v44, v44, v144
    v_mul_f32 v45, v45, v144
    v_mul_f32 v46, v46, v144
    v_mul_f32 v47, v47, v144
    v_mul_f32 v48, v48, v144
    v_mul_f32 v49, v49, v144
    v_cvt_pk_bf16_f32 v112, v42, v43
    v_cvt_pk_bf16_f32 v113, v44, v45
    v_cvt_pk_bf16_f32 v120, v46, v47
    v_cvt_pk_bf16_f32 v121, v48, v49
    buffer_store_dwordx4 v[110:113], v9, s[16:19], s66 offen offset:0 sc1
    s_mov_b64 exec, 0xffff
    buffer_store_dwordx4 v[118:121], v9, s[16:19], s67 offen offset:0 sc1
    s_mov_b64 exec, -1
    v_mul_f32 v54, v54, v146
    v_mul_f32 v55, v55, v146
    v_mul_f32 v56, v56, v146
    v_mul_f32 v57, v57, v146
    v_mul_f32 v58, v58, v146
    v_mul_f32 v59, v59, v146
    v_mul_f32 v60, v60, v146
    v_mul_f32 v61, v61, v146
    v_cvt_pk_bf16_f32 v126, v54, v55
    v_cvt_pk_bf16_f32 v127, v56, v57
    v_cvt_pk_bf16_f32 v134, v58, v59
    v_cvt_pk_bf16_f32 v135, v60, v61
    v_mul_f32 v66, v66, v148
    v_mul_f32 v67, v67, v148
    v_mul_f32 v68, v68, v148
    v_mul_f32 v69, v69, v148
    v_mul_f32 v70, v70, v148
    v_mul_f32 v71, v71, v148
    v_mul_f32 v72, v72, v148
    v_mul_f32 v73, v73, v148
    v_cvt_pk_bf16_f32 v128, v66, v67
    v_cvt_pk_bf16_f32 v129, v68, v69
    v_cvt_pk_bf16_f32 v136, v70, v71
    v_cvt_pk_bf16_f32 v137, v72, v73
    buffer_store_dwordx4 v[126:129], v9, s[16:19], s66 offen offset:1024 sc1
    s_mov_b64 exec, 0xffff
    buffer_store_dwordx4 v[134:137], v9, s[16:19], s67 offen offset:1024 sc1
    s_mov_b64 exec, -1
    s_waitcnt vmcnt(0)
Lp_32:
    s_barrier
    s_cmp_lg_u32 s62, 0
    s_cbranch_scc1 Lp_31
    v_mov_b32 v4, s82
    v_mov_b32 v5, s83
    v_lshlrev_b32 v6, 3, v1
    s_lshl_b32 s43, s43, 4
    s_add_u32 s43, s43, 4325376
    s_mov_b64 exec, 65535
    buffer_store_dwordx2 v[4:5], v6, s[28:31], s43 offen sc1
    s_mov_b64 exec, -1
Lp_31:
    s_add_u32 m0, s69, 4096
    s_mul_i32 s68, s93, 5120
    s_add_u32 s68, s68, 4096
    buffer_load_dwordx4 v9, s[24:27], s68 offen sc1 lds
    s_add_u32 m0, s69, 5120
    s_mul_i32 s68, s94, 5120
    s_add_u32 s68, s68, 0
    buffer_load_dwordx4 v9, s[24:27], s68 offen sc1 lds
    s_add_u32 m0, s69, 6144
    s_mul_i32 s68, s94, 5120
    s_add_u32 s68, s68, 1024
    buffer_load_dwordx4 v9, s[24:27], s68 offen sc1 lds
    s_add_u32 m0, s69, 7168
    s_mul_i32 s68, s94, 5120
    s_add_u32 s68, s68, 2048
    buffer_load_dwordx4 v9, s[24:27], s68 offen sc1 lds
    s_add_u32 m0, s3, 0
    s_mul_i32 s68, s94, 5120
    s_add_u32 s68, s68, 3072
    buffer_load_dwordx4 v9, s[24:27], s68 offen sc1 lds
    s_add_u32 m0, s3, 1024
    s_mul_i32 s68, s94, 5120
    s_add_u32 s68, s68, 4096
    buffer_load_dwordx4 v9, s[24:27], s68 offen sc1 lds
    s_add_u32 m0, s3, 3072
    s_mul_i32 s68, s95, 5120
    s_add_u32 s68, s68, 1024
    buffer_load_dwordx4 v9, s[24:27], s68 offen sc1 lds
    s_add_u32 m0, s3, 4096
    s_mul_i32 s68, s95, 5120
    s_add_u32 s68, s68, 2048
    buffer_load_dwordx4 v9, s[24:27], s68 offen sc1 lds
    s_add_u32 m0, s3, 5120
    s_mul_i32 s68, s95, 5120
    s_add_u32 s68, s68, 3072
    buffer_load_dwordx4 v9, s[24:27], s68 offen sc1 lds
    s_add_u32 m0, s3, 6144
    s_mul_i32 s68, s95, 5120
    s_add_u32 s68, s68, 4096
    buffer_load_dwordx4 v9, s[24:27], s68 offen sc1 lds
    s_add_u32 m0, s3, 7168
    s_mul_i32 s68, s96, 5120
    s_add_u32 s68, s68, 0
    buffer_load_dwordx4 v9, s[24:27], s68 offen sc1 lds
    s_add_u32 m0, s3, 8192
    s_mul_i32 s68, s96, 5120
    s_add_u32 s68, s68, 1024
    buffer_load_dwordx4 v9, s[24:27], s68 offen sc1 lds
    s_add_u32 m0, s3, 9216
    s_mul_i32 s68, s96, 5120
    s_add_u32 s68, s68, 2048
    buffer_load_dwordx4 v9, s[24:27], s68 offen sc1 lds
    s_add_u32 m0, s3, 10240
    s_mul_i32 s68, s96, 5120
    s_add_u32 s68, s68, 3072
    buffer_load_dwordx4 v9, s[24:27], s68 offen sc1 lds
    s_add_u32 m0, s3, 11264
    s_mul_i32 s68, s96, 5120
    s_add_u32 s68, s68, 4096
    buffer_load_dwordx4 v9, s[24:27], s68 offen sc1 lds
    s_add_u32 m0, s3, 2048
    s_mul_i32 s68, s95, 5120
    s_add_u32 s68, s68, 0
    buffer_load_dwordx4 v9, s[24:27], s68 offen sc1 lds
    s_branch Lphase2
Lffn:
    s_cmp_lt_u32 s62, 2
    s_cbranch_scc1 Lt_33
    s_lshl_b32 s42, s62, 12
    s_add_u32 s42, s42, 139264
    s_mul_i32 s73, s62, 49152
    s_sub_u32 s73, s73, 249856
    s_cmp_ge_u32 s62, 6
    s_cselect_b32 s42, s73, s42
    s_mul_i32 s66, s2, 6
    s_add_u32 s66, s66, s62
    s_sub_u32 s66, s66, 770
    s_min_u32 s66, s66, 739
    s_mul_i32 s70, s66, 886
    s_lshr_b32 s70, s70, 16
    s_mul_i32 s73, s70, 74
    s_sub_u32 s67, s66, s73
    v_lshrrev_b32 v4, 5, v1
    s_cmp_ge_u32 s67, 20
    s_cbranch_scc1 Lt_35
    s_cmp_ge_u32 s67, 10
    s_cselect_b32 s73, 10, 0
    s_cselect_b32 s74, 320, 0
    s_sub_u32 s73, s67, s73
    s_mul_i32 s75, s73, 40
    s_mul_i32 s76, s73, 160
    s_sub_u32 s76, s76, 1264
    s_cmp_lt_u32 s73, 8
    s_cselect_b32 s75, s75, s76
    s_cselect_b32 s76, 4, 40
    s_add_u32 s75, s75, s74
    v_mul_u32_u24 v232, s76, v4
    v_add_u32 v232, s75, v232
    s_lshl_b32 s76, s76, 1
    v_add_u32 v233, s76, v232
    v_mov_b32 v234, 20
    v_mov_b32 v235, 20
    s_waitcnt lgkmcnt(0)
    s_mov_b32 s20, s44
    s_mov_b32 s21, s45
    s_mov_b32 s22, 819200
    s_mov_b32 s23, 0x00020000
    s_branch Lt_36
Lt_35:
    s_sub_u32 s73, s67, 20
    s_mul_i32 s74, s73, 86
    s_lshr_b32 s74, s74, 8
    s_mul_i32 s74, s74, 3
    s_sub_u32 s74, s73, s74
    s_lshl_b32 s73, s73, 5
    v_lshl_add_u32 v232, v4, 2, s73
    s_cmp_eq_u32 s74, 1
    s_cselect_b32 s74, 16, 8
    s_cselect_b32 s75, 8, 16
    v_add_u32 v233, s74, v232
    v_mov_b32 v234, s75
    v_mov_b32 v235, s75
    s_waitcnt lgkmcnt(0)
    s_mov_b32 s20, s52
    s_mov_b32 s21, s53
    s_mov_b32 s22, 2211840
    s_mov_b32 s23, 0x00020000
Lt_36:
    v_bfe_u32 v5, v1, 3, 2
    v_and_b32 v6, 7, v1
    v_lshlrev_b32 v6, 4, v6
    s_lshl_b32 s73, s70, 7
    s_lshl_b32 s74, s62, 12
    v_add_u32 v7, v232, v5
    v_mul_u32_u24 v7, 1280, v7
    v_add3_u32 v236, v7, v6, s73
    v_add_u32 v7, v233, v5
    v_mul_u32_u24 v7, 1280, v7
    v_add3_u32 v237, v7, v6, s73
    v_add_u32 v7, v232, v5
    v_add_u32 v7, v7, v234
    v_mul_u32_u24 v7, 1280, v7
    v_add3_u32 v238, v7, v6, s73
    v_add_u32 v7, v233, v5
    v_add_u32 v7, v7, v235
    v_mul_u32_u24 v7, 1280, v7
    v_add3_u32 v239, v7, v6, s73
    s_add_u32 m0, s42, 0
    s_nop 0
    buffer_load_dwordx4 v236, s[20:23], 0 offen nt lds
    s_add_u32 m0, s42, 1024
    s_nop 0
    buffer_load_dwordx4 v237, s[20:23], 0 offen nt lds
    s_add_u32 m0, s42, 2048
    s_nop 0
    buffer_load_dwordx4 v238, s[20:23], 0 offen nt lds
    s_add_u32 m0, s42, 3072
    s_nop 0
    buffer_load_dwordx4 v239, s[20:23], 0 offen nt lds
    s_mul_i32 s75, s67, 5
    s_lshl_b32 s76, s70, 2
    s_add_u32 s73, s76, 0
    s_mul_i32 s74, s73, 52
    s_lshr_b32 s74, s74, 8
    s_mul_i32 s74, s74, 365
    s_add_u32 s73, s73, s74
    s_add_u32 s73, s73, s75
    s_lshl_b32 s44, s73, 10
    s_add_u32 s73, s76, 1
    s_mul_i32 s74, s73, 52
    s_lshr_b32 s74, s74, 8
    s_mul_i32 s74, s74, 365
    s_add_u32 s73, s73, s74
    s_add_u32 s73, s73, s75
    s_lshl_b32 s45, s73, 10
    s_add_u32 s73, s76, 2
    s_mul_i32 s74, s73, 52
    s_lshr_b32 s74, s74, 8
    s_mul_i32 s74, s74, 365
    s_add_u32 s73, s73, s74
    s_add_u32 s73, s73, s75
    s_lshl_b32 s52, s73, 10
    s_add_u32 s73, s76, 3
    s_mul_i32 s74, s73, 52
    s_lshr_b32 s74, s74, 8
    s_mul_i32 s74, s74, 365
    s_add_u32 s73, s73, s74
    s_add_u32 s73, s73, s75
    s_lshl_b32 s53, s73, 10
    s_branch Lt_33
Lt_34:
Lt_33:
    s_and_b32 s73, s2, 1
    s_bfe_u32 s74, s2, 0x20001
    s_lshr_b32 s75, s2, 3
    s_cmp_eq_u32 s62, 1
    s_cselect_b32 s87, 1966080, s87
    s_sub_u32 s75, s75, 16
    s_lshl_b32 s74, s74, 4
    s_add_u32 s74, s74, s75
    s_cmp_ge_u32 s74, 63
    s_cbranch_scc1 Lidle
    s_mul_i32 s64, s74, 37
    s_lshr_b32 s64, s64, 8
    s_sub_u32 s76, s64, s73
    s_mul_i32 s76, s76, 7
    s_sub_u32 s63, s74, s76
    s_mul_i32 s76, s63, 152
    s_mul_i32 s15, s64, 384
    s_lshl_b32 s73, s62, 4
    s_add_u32 s73, s73, s76
    s_max_i32 s73, s73, 0
    s_mul_i32 s12, s73, 1280
    s_sub_u32 s12, s12, 128
    s_lshl_b32 s73, s62, 3
    s_add_u32 s73, s73, s76
    s_mul_i32 s13, s73, 1280
    s_add_u32 s13, s13, 163712
    s_lshl_b32 s14, s62, 10
    s_add_u32 s14, s14, 16384
    v_lshrrev_b32 v4, 3, v1
    v_mul_u32_u24 v4, 1280, v4
    v_xor_b32 v5, v2, v1
    v_and_b32 v5, 7, v5
    v_lshl_add_u32 v11, v5, 4, v4
    v_xor_b32 v6, 64, v11
    v_add_u32 v12, 9216, v6
    s_and_b32 s73, s62, 1
    s_lshl_b32 s74, s73, 6
    v_xor_b32 v124, s74, v11
    s_lshl_b32 s73, s73, 2
    s_lshr_b32 s74, s62, 1
    s_lshl_b32 s74, s74, 4
    s_add_u32 s73, s73, s74
    s_mul_i32 s67, s73, 3456
    s_add_u32 s67, s67, s15
    s_sub_u32 s67, s67, 221184
    s_mov_b32 s100, -1
    s_mov_b32 s101, 0xffff
    s_mul_i32 s47, s62, 3072
    s_add_u32 s47, s47, 20480
    v_add_u32 v4, 0, v1
    v_mul_u32_u24 v5, 2731, v4
    v_lshrrev_b32 v5, 16, v5
    v_mul_u32_u24 v6, 24, v5
    v_sub_u32 v4, v4, v6
    v_and_b32 v6, 6, v5
    v_xor_b32 v4, v4, v6
    v_lshlrev_b32 v4, 4, v4
    v_and_b32 v6, 4, v5
    v_add_u32 v5, v5, v6
    v_mul_u32_u24 v5, 3456, v5
    v_add_u32 v4, v4, v5
    v_subrev_u32 v120, 0, v4
    v_add_u32 v4, 64, v1
    v_mul_u32_u24 v5, 2731, v4
    v_lshrrev_b32 v5, 16, v5
    v_mul_u32_u24 v6, 24, v5
    v_sub_u32 v4, v4, v6
    v_and_b32 v6, 6, v5
    v_xor_b32 v4, v4, v6
    v_lshlrev_b32 v4, 4, v4
    v_and_b32 v6, 4, v5
    v_add_u32 v5, v5, v6
    v_mul_u32_u24 v5, 3456, v5
    v_add_u32 v4, v4, v5
    v_subrev_u32 v121, 1024, v4
    v_add_u32 v4, 128, v1
    v_mul_u32_u24 v5, 2731, v4
    v_lshrrev_b32 v5, 16, v5
    v_mul_u32_u24 v6, 24, v5
    v_sub_u32 v4, v4, v6
    v_and_b32 v6, 6, v5
    v_xor_b32 v4, v4, v6
    v_lshlrev_b32 v4, 4, v4
    v_and_b32 v6, 4, v5
    v_add_u32 v5, v5, v6
    v_mul_u32_u24 v5, 3456, v5
    v_add_u32 v4, v4, v5
    v_subrev_u32 v122, 2048, v4
    s_mov_b32 s8, s48
    s_mov_b32 s9, s49
    s_mov_b32 s10, 2211840
    s_mov_b32 s11, 0x00020000
    s_mov_b32 s24, s50
    s_mov_b32 s25, s51
    s_mov_b32 s26, 3456
    s_mov_b32 s27, 0x00020000
    s_lshl_b32 s73, s63, 7
    s_lshl_b32 s74, s64, 3
    s_add_u32 s43, s73, s74
    s_mov_b32 s16, s60
    s_mov_b32 s17, s61
    s_mov_b32 s18, 9699328
    s_mov_b32 s19, 0x00020000
    s_add_u32 s28, s60, 11534336
    s_addc_u32 s29, s61, 0
    s_mov_b32 s30, 4587520
    s_mov_b32 s31, 0x00020000
    s_mov_b32 s32, s58
    s_mov_b32 s33, s59
    s_mov_b32 s34, 256
    s_mov_b32 s35, 0x00020000
    s_lshr_b32 s77, s62, 2
    s_bfe_u32 s73, s62, 0x10001
    s_and_b32 s74, s62, 1
    s_mul_i32 s73, s73, 6
    s_lshl_b32 s75, s74, 2
    s_add_u32 s78, s73, s75
    s_add_u32 s79, s78, 1
    s_add_u32 s80, s73, s74
    s_add_u32 s80, s80, 2
    s_cmp_eq_u32 s77, 0
    s_cselect_b32 s84, -1, 0x7fff7fff
    s_cselect_b32 s85, -1, 0x7fff7fff
    v_lshrrev_b32 v4, 1, v3
    v_xor_b32 v4, v4, v2
    v_lshlrev_b32 v4, 4, v4
    v_lshl_add_u32 v4, v3, 7, v4
    s_mul_i32 s73, s77, 10240
    s_add_u32 s73, s73, 49152
    v_add_u32 v13, s73, v4
    v_xor_b32 v14, 64, v13
    v_bfe_u32 v4, v1, 2, 3
    v_lshrrev_b32 v5, 5, v1
    v_lshl_add_u32 v4, v5, 4, v4
    v_bfe_u32 v6, v4, 1, 2
    v_mul_u32_u24 v4, 384, v4
    v_and_b32 v5, 3, v1
    v_lshl_add_u32 v4, v5, 3, v4
    v_add_u32 v4, 69632, v4
    v_xor_b32 v5, s78, v6
    v_lshl_add_u32 v17, v5, 5, v4
    v_xor_b32 v5, s79, v6
    v_lshl_add_u32 v18, v5, 5, v4
    v_xor_b32 v5, s80, v6
    v_lshl_add_u32 v19, v5, 5, v4
    s_mul_i32 s73, s63, 152
    s_mul_i32 s74, s77, 80
    s_add_u32 s73, s73, s74
    v_add_u32 v15, s73, v3
    v_lshlrev_b32 v4, 5, v15
    v_add_u32 v21, 4456448, v4
    v_mov_b32 v152, 0x3f803f80
    v_mov_b32 v153, 0x3f803f80
    v_mov_b32 v154, 0x3f803f80
    v_mov_b32 v155, 0x3f803f80
    v_mov_b32 v172, 0x3f803f80
    v_mov_b32 v173, 0x3f803f80
    v_mov_b32 v174, 0x3f803f80
    v_mov_b32 v175, 0x3f803f80
    v_lshlrev_b32 v4, 3, v2
    s_mul_i32 s75, s64, 384
    s_lshl_b32 s74, s78, 5
    s_add_u32 s74, s74, s75
    buffer_load_dwordx2 v[48:49], v4, s[24:27], s74 offen
    s_lshl_b32 s74, s79, 5
    s_add_u32 s74, s74, s75
    buffer_load_dwordx2 v[50:51], v4, s[24:27], s74 offen
    s_lshl_b32 s74, s80, 5
    s_add_u32 s74, s74, s75
    buffer_load_dwordx2 v[52:53], v4, s[24:27], s74 offen
    s_and_b32 s73, s2, 7
    s_lshl_b32 s50, s73, 2
    s_bfe_u32 s74, s2, 0x20003
    s_add_u32 s50, s50, s74
    s_lshr_b32 s51, s2, 5
    s_lshl_b32 s74, s74, 1
    s_mul_i32 s73, s51, 2
    s_lshr_b32 s73, s73, 1
    s_add_u32 s74, s74, s73
    s_cmp_lt_u32 s62, 2
    s_cselect_b32 s99, 10, 9
    s_cmp_ge_u32 s74, s99
    s_cselect_b32 s75, s99, 0
    s_sub_u32 s88, s74, s75
    s_add_u32 s89, s88, 1
    s_cmp_eq_u32 s89, s99
    s_cselect_b32 s89, 0, s89
    s_add_u32 s90, s89, 1
    s_cmp_eq_u32 s90, s99
    s_cselect_b32 s90, 0, s90
    s_add_u32 s91, s90, 1
    s_cmp_eq_u32 s91, s99
    s_cselect_b32 s91, 0, s91
    s_add_u32 s92, s91, 1
    s_cmp_eq_u32 s92, s99
    s_cselect_b32 s92, 0, s92
    s_add_u32 s93, s92, 1
    s_cmp_eq_u32 s93, s99
    s_cselect_b32 s93, 0, s93
    s_add_u32 s94, s93, 1
    s_cmp_eq_u32 s94, s99
    s_cselect_b32 s94, 0, s94
    s_add_u32 s95, s94, 1
    s_cmp_eq_u32 s95, s99
    s_cselect_b32 s95, 0, s95
    s_add_u32 s96, s95, 1
    s_cmp_eq_u32 s96, s99
    s_cselect_b32 s96, 0, s96
    s_add_u32 s97, s96, 1
    s_cmp_eq_u32 s97, s99
    s_cselect_b32 s97, 0, s97
    s_mul_i32 s76, s62, 9
    s_min_u32 s75, s62, 2
    s_add_u32 s76, s76, s75
    v_lshrrev_b32 v4, 1, v1
    s_sub_u32 s75, s99, 1
    v_min_u32 v4, s75, v4
    v_add_u32 v4, s76, v4
    s_mul_i32 s75, s51, 5
    s_lshr_b32 s75, s75, 2
    s_mul_i32 s75, s75, 74
    v_and_b32 v5, 1, v1
    v_mul_u32_u24 v5, 74, v5
    v_add3_u32 v4, v4, v5, s75
    v_mul_u32_u24 v4, 10923, v4
    v_lshrrev_b32 v4, 16, v4
    v_lshlrev_b32 v4, 7, v4
    v_add_u32 v20, 4198400, v4
    s_mul_i32 s75, s51, 74
    s_add_u32 s75, s75, s76
    s_mul_i32 s75, s75, 5120
    s_add_u32 s75, s75, 11534336
    s_add_u32 s24, s60, s75
    s_addc_u32 s25, s61, 0
    s_mul_i32 s26, s99, 5120
    s_mov_b32 s27, 0x00020000
    s_mul_i32 s75, s50, 74
    s_add_u32 s75, s75, s76
    s_lshl_b32 s75, s75, 12
    s_add_u32 s20, s60, s75
    s_addc_u32 s21, s61, 0
    s_lshl_b32 s22, s99, 12
    s_mov_b32 s23, 0x00020000
    s_cmp_ge_u32 s62, 2
    s_cbranch_scc1 Ly_37
    s_lshr_b32 s73, s50, 1
    s_lshl_b32 s73, s73, 7
    s_lshl_b32 s74, s62, 5
    s_add_u32 s73, s73, s74
    s_add_u32 s73, s73, 2048
    v_and_b32 v4, 3, v1
    v_lshl_add_u32 v0, v4, 3, s73
    s_branch Ly_38
Ly_37:
    s_lshl_b32 s73, s50, 6
    s_add_u32 s74, s73, 63
    s_mul_i32 s73, s73, 27595
    s_lshr_b32 s73, s73, 22
    s_mul_i32 s74, s74, 27595
    s_lshr_b32 s74, s74, 22
    s_sub_u32 s74, s74, s73
    s_lshl_b32 s74, s74, 7
    s_lshl_b32 s73, s73, 7
    s_sub_u32 s75, s62, 2
    s_mul_i32 s75, s75, 3
    s_lshr_b32 s75, s75, 1
    s_lshl_b32 s75, s75, 3
    s_add_u32 s73, s73, s75
    v_and_b32 v4, 1, v1
    v_lshlrev_b32 v4, 3, v4
    v_bfe_u32 v5, v1, 1, 1
    v_mul_u32_u24 v5, s74, v5
    v_add3_u32 v0, v4, v5, s73
Ly_38:
    v_lshlrev_b32 v0, 4, v0
    v_add_u32 v0, 4325376, v0
    s_lshl_b32 s73, s50, 6
    v_add_u32 v4, s73, v3
    v_mul_u32_u24 v4, 1280, v4
    v_lshl_add_u32 v4, v2, 3, v4
    s_mul_i32 s73, s51, 160
    v_add_u32 v10, s73, v4
    s_cmp_lt_u32 s62, 4
    s_cselect_b64 vcc, -1, 0
    s_barrier
    s_mov_b32 s69, 49152
    s_add_u32 m0, s69, s72
    s_add_u32 s12, s12, 128
    buffer_load_dwordx4 v11, s[4:7], s12 offen lds
    buffer_load_dwordx4 v12, s[4:7], s12 offen offset:1024 lds
    s_cbranch_vccz Lsk_39
    s_add_u32 m0, s69, s14
    s_add_u32 s13, s13, 128
    buffer_load_dwordx4 v124, s[4:7], s13 offen lds
Lsk_39:
    s_add_u32 m0, s69, s47
    s_add_u32 s67, s67, 221184
    buffer_load_dwordx4 v120, s[8:11], s67 offen offset:0 lds
    buffer_load_dwordx4 v121, s[8:11], s67 offen offset:1024 lds
    buffer_load_dwordx4 v122, s[8:11], s67 offen offset:2048 lds
    s_waitcnt vmcnt(5)
    s_cmp_lt_u32 s62, 2
    s_cbranch_scc1 Ltw_40
    v_lshrrev_b32 v4, 2, v1
    v_lshlrev_b32 v4, 7, v4
    v_and_b32 v5, 3, v1
    v_lshl_add_u32 v4, v5, 3, v4
    v_add_u32 v4, s42, v4
    ds_read_b64_tr_b16 v[232:233], v4 offset:0
    ds_read_b64_tr_b16 v[234:235], v4 offset:2048
    ds_read_b64_tr_b16 v[236:237], v4 offset:32
    ds_read_b64_tr_b16 v[238:239], v4 offset:2080
    ds_read_b64_tr_b16 v[240:241], v4 offset:64
    ds_read_b64_tr_b16 v[242:243], v4 offset:2112
    ds_read_b64_tr_b16 v[244:245], v4 offset:96
    ds_read_b64_tr_b16 v[246:247], v4 offset:2144
    s_waitcnt lgkmcnt(6)
    buffer_store_dwordx4 v[232:235], v9, s[28:31], s44 offen sc1
    s_waitcnt lgkmcnt(4)
    buffer_store_dwordx4 v[236:239], v9, s[28:31], s45 offen sc1
    s_waitcnt lgkmcnt(2)
    buffer_store_dwordx4 v[240:243], v9, s[28:31], s52 offen sc1
    s_waitcnt lgkmcnt(0)
    buffer_store_dwordx4 v[244:247], v9, s[28:31], s53 offen sc1
Ltw_40:
    v_mov_b32 v4, 0
    buffer_load_dwordx2 v[26:27], v4, s[32:35], 0 offen sc1
    s_barrier
    s_mov_b32 s69, 98304
    s_add_u32 m0, s69, s72
    s_add_u32 s12, s12, 128
    buffer_load_dwordx4 v11, s[4:7], s12 offen lds
    buffer_load_dwordx4 v12, s[4:7], s12 offen offset:1024 lds
    s_cbranch_vccz Lsk_41
    s_add_u32 m0, s69, s14
    s_add_u32 s13, s13, 128
    buffer_load_dwordx4 v124, s[4:7], s13 offen lds
Lsk_41:
    s_add_u32 m0, s69, s47
    s_add_u32 s67, s67, 221184
    s_waitcnt vmcnt(3)
    s_barrier
    ds_read_b128 v[136:139], v13 offset:0
    ds_read_b128 v[140:143], v13 offset:2048
    ds_read_b128 v[144:147], v13 offset:4096
    ds_read_b128 v[148:151], v13 offset:6144
    s_mov_b64 exec, s[84:85]
    ds_read_b128 v[152:155], v13 offset:8192
    s_mov_b64 exec, -1
    ds_read_b64_tr_b16 v[176:177], v17 offset:0
    ds_read_b64_tr_b16 v[178:179], v17 offset:3072
    ds_read_b64_tr_b16 v[180:181], v18 offset:0
    ds_read_b64_tr_b16 v[182:183], v18 offset:3072
    ds_read_b64_tr_b16 v[184:185], v19 offset:0
    ds_read_b64_tr_b16 v[186:187], v19 offset:3072
    s_mov_b32 s71, 49152
    s_waitcnt lgkmcnt(0)
    v_mfma_f32_16x16x32_bf16 v[56:59], v[176:179], v[136:139], 0
    s_setprio 1
    s_add_u32 s74, s71, 49152
    s_cmp_eq_u32 s74, 147456
    s_cselect_b32 s74, 0, s74
    buffer_load_dwordx4 v120, s[8:11], s67 offen offset:0 lds
    buffer_load_dwordx4 v121, s[8:11], s67 offen offset:1024 lds
    ds_read_b128 v[156:159], v14 offset:0
    ds_read_b128 v[160:163], v14 offset:2048
    v_mfma_f32_16x16x32_bf16 v[60:63], v[176:179], v[140:143], 0
    s_sub_u32 s70, s74, s71
    buffer_load_dwordx4 v122, s[8:11], s67 offen offset:2048 lds
    ds_read_b128 v[164:167], v14 offset:4096
    v_mfma_f32_16x16x32_bf16 v[64:67], v[176:179], v[144:147], 0
    s_mov_b32 s69, 0
    s_add_u32 m0, s69, s72
    s_add_u32 s12, s12, 128
    ds_read_b128 v[168:171], v14 offset:6144
    v_mfma_f32_16x16x32_bf16 v[68:71], v[176:179], v[148:151], 0
    s_mov_b64 exec, s[84:85]
    ds_read_b128 v[172:175], v14 offset:8192
    s_mov_b64 exec, -1
    v_mfma_f32_16x16x32_bf16 v[72:75], v[176:179], v[152:155], 0
    buffer_load_dwordx4 v11, s[4:7], s12 offen lds
    buffer_load_dwordx4 v12, s[4:7], s12 offen offset:1024 lds
    v_mfma_f32_16x16x32_bf16 v[76:79], v[180:183], v[136:139], 0
    s_cbranch_vccz Lsk_42
    s_add_u32 m0, s69, s14
    s_add_u32 s13, s13, 128
    buffer_load_dwordx4 v124, s[4:7], s13 offen lds
Lsk_42:
    v_add_u32 v14, s70, v14
    v_mfma_f32_16x16x32_bf16 v[80:83], v[180:183], v[140:143], 0
    ds_read_b64_tr_b16 v[188:189], v17 offset:12288
    ds_read_b64_tr_b16 v[190:191], v17 offset:15360
    v_mfma_f32_16x16x32_bf16 v[84:87], v[180:183], v[144:147], 0
    s_setprio 0
    ds_read_b64_tr_b16 v[192:193], v18 offset:12288
    v_mfma_f32_16x16x32_bf16 v[88:91], v[180:183], v[148:151], 0
    ds_read_b64_tr_b16 v[194:195], v18 offset:15360
    v_mfma_f32_16x16x32_bf16 v[92:95], v[180:183], v[152:155], 0
    s_add_u32 m0, s69, s47
    s_add_u32 s67, s67, 221184
    v_add_u32 v17, s70, v17
    ds_read_b64_tr_b16 v[196:197], v19 offset:12288
    v_mfma_f32_16x16x32_bf16 v[96:99], v[184:187], v[136:139], 0
    buffer_load_dwordx4 v120, s[8:11], s67 offen offset:0 lds
    ds_read_b64_tr_b16 v[198:199], v19 offset:15360
    v_mfma_f32_16x16x32_bf16 v[100:103], v[184:187], v[140:143], 0
    buffer_load_dwordx4 v121, s[8:11], s67 offen offset:1024 lds
    buffer_load_dwordx4 v122, s[8:11], s67 offen offset:2048 lds
    v_add_u32 v18, s70, v18
    v_mfma_f32_16x16x32_bf16 v[104:107], v[184:187], v[144:147], 0
    s_mov_b32 s69, s71
    v_add_u32 v19, s70, v19
    v_mfma_f32_16x16x32_bf16 v[108:111], v[184:187], v[148:151], 0
    s_mov_b32 s71, s74
    v_add_u32 v13, s70, v13
    v_mfma_f32_16x16x32_bf16 v[112:115], v[184:187], v[152:155], 0
    s_waitcnt vmcnt(5) lgkmcnt(0)
    s_barrier
    s_setprio 3
    v_mfma_f32_16x16x32_bf16 v[56:59], v[188:191], v[156:159], v[56:59]
    s_bitcmp1_b32 3, s65
    s_cbranch_scc0 Ldu_43
    s_cmp_ge_u32 s46, s87
    s_cbranch_scc1 Ldu_43
    buffer_load_dword v255, v254, s[36:39], s46 offen
    s_add_u32 s46, s46, s86
    s_cmp_ge_u32 s46, s87
    s_cbranch_scc1 Ldu_43
    buffer_load_dword v255, v254, s[36:39], s46 offen
    s_add_u32 s46, s46, s86
Ldu_43:
    ds_read_b128 v[136:139], v13 offset:0
    ds_read_b128 v[140:143], v13 offset:2048
    v_mfma_f32_16x16x32_bf16 v[60:63], v[188:191], v[160:163], v[60:63]
    ds_read_b128 v[144:147], v13 offset:4096
    v_mfma_f32_16x16x32_bf16 v[64:67], v[188:191], v[164:167], v[64:67]
    ds_read_b128 v[148:151], v13 offset:6144
    v_mfma_f32_16x16x32_bf16 v[68:71], v[188:191], v[168:171], v[68:71]
    s_mov_b64 exec, s[84:85]
    ds_read_b128 v[152:155], v13 offset:8192
    s_mov_b64 exec, -1
    v_mfma_f32_16x16x32_bf16 v[72:75], v[188:191], v[172:175], v[72:75]
    v_mfma_f32_16x16x32_bf16 v[76:79], v[192:195], v[156:159], v[76:79]
    v_mfma_f32_16x16x32_bf16 v[80:83], v[192:195], v[160:163], v[80:83]
    s_add_u32 m0, s69, s72
    s_add_u32 s12, s12, 128
    ds_read_b64_tr_b16 v[176:177], v17 offset:0
    v_mfma_f32_16x16x32_bf16 v[84:87], v[192:195], v[164:167], v[84:87]
    buffer_load_dwordx4 v11, s[4:7], s12 offen lds
    ds_read_b64_tr_b16 v[178:179], v17 offset:3072
    s_setprio 2
    v_mfma_f32_16x16x32_bf16 v[88:91], v[192:195], v[168:171], v[88:91]
    buffer_load_dwordx4 v12, s[4:7], s12 offen offset:1024 lds
    s_cbranch_vccz Lsk_44
    s_add_u32 m0, s69, s14
    s_add_u32 s13, s13, 128
    buffer_load_dwordx4 v124, s[4:7], s13 offen lds
Lsk_44:
    ds_read_b64_tr_b16 v[180:181], v18 offset:0
    v_mfma_f32_16x16x32_bf16 v[92:95], v[192:195], v[172:175], v[92:95]
    ds_read_b64_tr_b16 v[182:183], v18 offset:3072
    v_mfma_f32_16x16x32_bf16 v[96:99], v[196:199], v[156:159], v[96:99]
    ds_read_b64_tr_b16 v[184:185], v19 offset:0
    v_mfma_f32_16x16x32_bf16 v[100:103], v[196:199], v[160:163], v[100:103]
    s_add_u32 m0, s69, s47
    s_add_u32 s67, s67, 221184
    ds_read_b64_tr_b16 v[186:187], v19 offset:3072
    v_mfma_f32_16x16x32_bf16 v[104:107], v[196:199], v[164:167], v[104:107]
    v_mfma_f32_16x16x32_bf16 v[108:111], v[196:199], v[168:171], v[108:111]
    v_mfma_f32_16x16x32_bf16 v[112:115], v[196:199], v[172:175], v[112:115]
    s_mov_b32 s98, 0
Lno_45:
    v_readfirstlane_b32 s82, v26
    v_readfirstlane_b32 s83, v27
    s_add_u32 s98, s98, 1
    s_cmp_gt_u32 s98, 100000
    s_cbranch_scc1 Lno_46
    s_cmp_lg_u32 s82, 0
    s_cbranch_scc1 Lno_46
    v_mov_b32 v4, 0
    buffer_load_dwordx2 v[26:27], v4, s[32:35], 0 offen sc1
    s_waitcnt vmcnt(0)
    s_branch Lno_45
Lno_46:
    s_cmp_lg_u32 s62, 0
    s_cbranch_scc1 Lno_47
    s_lshl_b32 s74, s2, 7
    s_add_u32 s74, s74, 4182016
    v_lshlrev_b32 v4, 3, v1
    s_mov_b64 exec, 65535
    buffer_store_dwordx2 v[26:27], v4, s[28:31], s74 offen sc1
    s_mov_b64 exec, -1
Lno_47:
    s_mov_b32 s65, 1
Lloop_f:
    s_waitcnt lgkmcnt(0)
    v_mfma_f32_16x16x32_bf16 v[56:59], v[176:179], v[136:139], v[56:59]
    s_setprio 1
    s_add_u32 s74, s71, 49152
    s_cmp_eq_u32 s74, 147456
    s_cselect_b32 s74, 0, s74
    ds_read_b128 v[156:159], v14 offset:0
    ds_read_b128 v[160:163], v14 offset:2048
    v_mfma_f32_16x16x32_bf16 v[60:63], v[176:179], v[140:143], v[60:63]
    s_sub_u32 s70, s74, s71
    ds_read_b128 v[164:167], v14 offset:4096
    v_mfma_f32_16x16x32_bf16 v[64:67], v[176:179], v[144:147], v[64:67]
    buffer_load_dwordx4 v120, s[8:11], s67 offen offset:0 lds
    ds_read_b128 v[168:171], v14 offset:6144
    v_mfma_f32_16x16x32_bf16 v[68:71], v[176:179], v[148:151], v[68:71]
    s_mov_b64 exec, s[84:85]
    ds_read_b128 v[172:175], v14 offset:8192
    s_mov_b64 exec, -1
    v_mfma_f32_16x16x32_bf16 v[72:75], v[176:179], v[152:155], v[72:75]
    buffer_load_dwordx4 v121, s[8:11], s67 offen offset:1024 lds
    v_mfma_f32_16x16x32_bf16 v[76:79], v[180:183], v[136:139], v[76:79]
    v_add_u32 v14, s70, v14
    v_mfma_f32_16x16x32_bf16 v[80:83], v[180:183], v[140:143], v[80:83]
    buffer_load_dwordx4 v122, s[8:11], s67 offen offset:2048 lds
    ds_read_b64_tr_b16 v[188:189], v17 offset:12288
    ds_read_b64_tr_b16 v[190:191], v17 offset:15360
    v_mfma_f32_16x16x32_bf16 v[84:87], v[180:183], v[144:147], v[84:87]
    s_setprio 0
    ds_read_b64_tr_b16 v[192:193], v18 offset:12288
    v_mfma_f32_16x16x32_bf16 v[88:91], v[180:183], v[148:151], v[88:91]
    ds_read_b64_tr_b16 v[194:195], v18 offset:15360
    v_mfma_f32_16x16x32_bf16 v[92:95], v[180:183], v[152:155], v[92:95]
    s_mov_b32 s69, s71
    v_add_u32 v17, s70, v17
    ds_read_b64_tr_b16 v[196:197], v19 offset:12288
    v_mfma_f32_16x16x32_bf16 v[96:99], v[184:187], v[136:139], v[96:99]
    ds_read_b64_tr_b16 v[198:199], v19 offset:15360
    v_mfma_f32_16x16x32_bf16 v[100:103], v[184:187], v[140:143], v[100:103]
    s_mov_b32 s71, s74
    v_add_u32 v18, s70, v18
    v_mfma_f32_16x16x32_bf16 v[104:107], v[184:187], v[144:147], v[104:107]
    v_add_u32 v19, s70, v19
    v_mfma_f32_16x16x32_bf16 v[108:111], v[184:187], v[148:151], v[108:111]
    v_add_u32 v13, s70, v13
    v_mfma_f32_16x16x32_bf16 v[112:115], v[184:187], v[152:155], v[112:115]
    s_waitcnt vmcnt(5) lgkmcnt(0)
    s_barrier
    s_setprio 3
    v_mfma_f32_16x16x32_bf16 v[56:59], v[188:191], v[156:159], v[56:59]
    s_bitcmp1_b32 3, s65
    s_cbranch_scc0 Ldu_49
    s_cmp_ge_u32 s46, s87
    s_cbranch_scc1 Ldu_49
    buffer_load_dword v255, v254, s[36:39], s46 offen
    s_add_u32 s46, s46, s86
    s_cmp_ge_u32 s46, s87
    s_cbranch_scc1 Ldu_49
    buffer_load_dword v255, v254, s[36:39], s46 offen
    s_add_u32 s46, s46, s86
Ldu_49:
    ds_read_b128 v[136:139], v13 offset:0
    ds_read_b128 v[140:143], v13 offset:2048
    v_mfma_f32_16x16x32_bf16 v[60:63], v[188:191], v[160:163], v[60:63]
    ds_read_b128 v[144:147], v13 offset:4096
    v_mfma_f32_16x16x32_bf16 v[64:67], v[188:191], v[164:167], v[64:67]
    ds_read_b128 v[148:151], v13 offset:6144
    v_mfma_f32_16x16x32_bf16 v[68:71], v[188:191], v[168:171], v[68:71]
    s_mov_b64 exec, s[84:85]
    ds_read_b128 v[152:155], v13 offset:8192
    s_mov_b64 exec, -1
    v_mfma_f32_16x16x32_bf16 v[72:75], v[188:191], v[172:175], v[72:75]
    v_mfma_f32_16x16x32_bf16 v[76:79], v[192:195], v[156:159], v[76:79]
    v_mfma_f32_16x16x32_bf16 v[80:83], v[192:195], v[160:163], v[80:83]
    s_add_u32 m0, s69, s72
    s_add_u32 s12, s12, 128
    ds_read_b64_tr_b16 v[176:177], v17 offset:0
    v_mfma_f32_16x16x32_bf16 v[84:87], v[192:195], v[164:167], v[84:87]
    buffer_load_dwordx4 v11, s[4:7], s12 offen lds
    ds_read_b64_tr_b16 v[178:179], v17 offset:3072
    s_setprio 2
    v_mfma_f32_16x16x32_bf16 v[88:91], v[192:195], v[168:171], v[88:91]
    buffer_load_dwordx4 v12, s[4:7], s12 offen offset:1024 lds
    s_cbranch_vccz Lsk_50
    s_add_u32 m0, s69, s14
    s_add_u32 s13, s13, 128
    buffer_load_dwordx4 v124, s[4:7], s13 offen lds
Lsk_50:
    ds_read_b64_tr_b16 v[180:181], v18 offset:0
    v_mfma_f32_16x16x32_bf16 v[92:95], v[192:195], v[172:175], v[92:95]
    ds_read_b64_tr_b16 v[182:183], v18 offset:3072
    v_mfma_f32_16x16x32_bf16 v[96:99], v[196:199], v[156:159], v[96:99]
    ds_read_b64_tr_b16 v[184:185], v19 offset:0
    v_mfma_f32_16x16x32_bf16 v[100:103], v[196:199], v[160:163], v[100:103]
    s_add_u32 m0, s69, s47
    s_add_u32 s67, s67, 221184
    ds_read_b64_tr_b16 v[186:187], v19 offset:3072
    v_mfma_f32_16x16x32_bf16 v[104:107], v[196:199], v[164:167], v[104:107]
    s_bitcmp1_b32 32, s65
    s_cbranch_scc1 Lspec_f
Lret_f:
    v_mfma_f32_16x16x32_bf16 v[108:111], v[196:199], v[168:171], v[108:111]
    s_add_u32 s65, s65, 1
    s_cmp_lt_u32 s65, 7
    v_mfma_f32_16x16x32_bf16 v[112:115], v[196:199], v[172:175], v[112:115]
    s_cbranch_scc1 Lloop_f
    s_branch Lpost_f
Lspec_f:
    buffer_load_dwordx2 v[26:27], v20, s[28:31], 0 offen sc1
    s_branch Lret_f
Lpost_f:
    s_waitcnt lgkmcnt(0)
    v_mfma_f32_16x16x32_bf16 v[56:59], v[176:179], v[136:139], v[56:59]
    s_setprio 1
    s_add_u32 s74, s71, 49152
    s_cmp_eq_u32 s74, 147456
    s_cselect_b32 s74, 0, s74
    ds_read_b128 v[156:159], v14 offset:0
    ds_read_b128 v[160:163], v14 offset:2048
    v_mfma_f32_16x16x32_bf16 v[60:63], v[176:179], v[140:143], v[60:63]
    s_sub_u32 s70, s74, s71
    ds_read_b128 v[164:167], v14 offset:4096
    v_mfma_f32_16x16x32_bf16 v[64:67], v[176:179], v[144:147], v[64:67]
    buffer_load_dwordx4 v120, s[8:11], s67 offen offset:0 lds
    ds_read_b128 v[168:171], v14 offset:6144
    v_mfma_f32_16x16x32_bf16 v[68:71], v[176:179], v[148:151], v[68:71]
    s_mov_b64 exec, s[84:85]
    ds_read_b128 v[172:175], v14 offset:8192
    s_mov_b64 exec, -1
    v_mfma_f32_16x16x32_bf16 v[72:75], v[176:179], v[152:155], v[72:75]
    v_mfma_f32_16x16x32_bf16 v[76:79], v[180:183], v[136:139], v[76:79]
    buffer_load_dwordx4 v121, s[8:11], s67 offen offset:1024 lds
    v_add_u32 v14, s70, v14
    v_mfma_f32_16x16x32_bf16 v[80:83], v[180:183], v[140:143], v[80:83]
    ds_read_b64_tr_b16 v[188:189], v17 offset:12288
    ds_read_b64_tr_b16 v[190:191], v17 offset:15360
    v_mfma_f32_16x16x32_bf16 v[84:87], v[180:183], v[144:147], v[84:87]
    s_setprio 0
    ds_read_b64_tr_b16 v[192:193], v18 offset:12288
    v_mfma_f32_16x16x32_bf16 v[88:91], v[180:183], v[148:151], v[88:91]
    buffer_load_dwordx4 v122, s[8:11], s67 offen offset:2048 lds
    ds_read_b64_tr_b16 v[194:195], v18 offset:15360
    v_mfma_f32_16x16x32_bf16 v[92:95], v[180:183], v[152:155], v[92:95]
    v_add_u32 v17, s70, v17
    ds_read_b64_tr_b16 v[196:197], v19 offset:12288
    v_mfma_f32_16x16x32_bf16 v[96:99], v[184:187], v[136:139], v[96:99]
    ds_read_b64_tr_b16 v[198:199], v19 offset:15360
    v_mfma_f32_16x16x32_bf16 v[100:103], v[184:187], v[140:143], v[100:103]
    s_mov_b32 s71, s74
    v_add_u32 v18, s70, v18
    v_mfma_f32_16x16x32_bf16 v[104:107], v[184:187], v[144:147], v[104:107]
    v_add_u32 v19, s70, v19
    v_mfma_f32_16x16x32_bf16 v[108:111], v[184:187], v[148:151], v[108:111]
    v_add_u32 v13, s70, v13
    v_mfma_f32_16x16x32_bf16 v[112:115], v[184:187], v[152:155], v[112:115]
    s_waitcnt vmcnt(5) lgkmcnt(0)
    s_barrier
    s_setprio 3
    s_mov_b32 s98, 0
    s_branch Lpo_54
Lpo_52:
    buffer_load_dwordx2 v[26:27], v20, s[28:31], 0 offen sc1
    s_waitcnt vmcnt(0)
Lpo_54:
    v_cmp_eq_u64 vcc, s[82:83], v[26:27]
    s_add_u32 s98, s98, 1
    s_cmp_gt_u32 s98, 100000
    s_cbranch_scc1 Lpo_53
    s_cmp_eq_u64 vcc, -1
    s_cbranch_scc0 Lpo_52
Lpo_53:
    s_lshl_b32 s69, s62, 13
    s_add_u32 s69, s69, 98304
    s_mul_i32 s3, s62, 12288
    v_mfma_f32_16x16x32_bf16 v[56:59], v[188:191], v[156:159], v[56:59]
    s_mul_i32 s68, s91, 5120
    ds_read_b128 v[136:139], v13 offset:0
    ds_read_b128 v[140:143], v13 offset:2048
    v_mfma_f32_16x16x32_bf16 v[60:63], v[188:191], v[160:163], v[60:63]
    ds_read_b128 v[144:147], v13 offset:4096
    v_mfma_f32_16x16x32_bf16 v[64:67], v[188:191], v[164:167], v[64:67]
    ds_read_b128 v[148:151], v13 offset:6144
    v_mfma_f32_16x16x32_bf16 v[68:71], v[188:191], v[168:171], v[68:71]
    buffer_load_dwordx4 v[216:219], v9, s[24:27], s68 offen offset:0 sc1
    s_mov_b64 exec, s[84:85]
    ds_read_b128 v[152:155], v13 offset:8192
    s_mov_b64 exec, -1
    v_mfma_f32_16x16x32_bf16 v[72:75], v[188:191], v[172:175], v[72:75]
    v_mfma_f32_16x16x32_bf16 v[76:79], v[192:195], v[156:159], v[76:79]
    v_mfma_f32_16x16x32_bf16 v[80:83], v[192:195], v[160:163], v[80:83]
    s_mul_i32 s68, s91, 5120
    ds_read_b64_tr_b16 v[176:177], v17 offset:0
    v_mfma_f32_16x16x32_bf16 v[84:87], v[192:195], v[164:167], v[84:87]
    ds_read_b64_tr_b16 v[178:179], v17 offset:3072
    s_setprio 2
    v_mfma_f32_16x16x32_bf16 v[88:91], v[192:195], v[168:171], v[88:91]
    ds_read_b64_tr_b16 v[180:181], v18 offset:0
    v_mfma_f32_16x16x32_bf16 v[92:95], v[192:195], v[172:175], v[92:95]
    buffer_load_dwordx4 v[220:223], v9, s[24:27], s68 offen offset:1024 sc1
    ds_read_b64_tr_b16 v[182:183], v18 offset:3072
    v_mfma_f32_16x16x32_bf16 v[96:99], v[196:199], v[156:159], v[96:99]
    ds_read_b64_tr_b16 v[184:185], v19 offset:0
    v_mfma_f32_16x16x32_bf16 v[100:103], v[196:199], v[160:163], v[100:103]
    ds_read_b64_tr_b16 v[186:187], v19 offset:3072
    v_mfma_f32_16x16x32_bf16 v[104:107], v[196:199], v[164:167], v[104:107]
    v_mfma_f32_16x16x32_bf16 v[108:111], v[196:199], v[168:171], v[108:111]
    v_mfma_f32_16x16x32_bf16 v[112:115], v[196:199], v[172:175], v[112:115]
    s_add_u32 s65, s65, 1
    s_waitcnt lgkmcnt(0)
    v_mfma_f32_16x16x32_bf16 v[56:59], v[176:179], v[136:139], v[56:59]
    s_setprio 1
    s_add_u32 s74, s71, 49152
    s_cmp_eq_u32 s74, 147456
    s_cselect_b32 s74, 0, s74
    ds_read_b128 v[156:159], v14 offset:0
    ds_read_b128 v[160:163], v14 offset:2048
    v_mfma_f32_16x16x32_bf16 v[60:63], v[176:179], v[140:143], v[60:63]
    s_sub_u32 s70, s74, s71
    ds_read_b128 v[164:167], v14 offset:4096
    v_mfma_f32_16x16x32_bf16 v[64:67], v[176:179], v[144:147], v[64:67]
    s_mul_i32 s68, s91, 5120
    ds_read_b128 v[168:171], v14 offset:6144
    v_mfma_f32_16x16x32_bf16 v[68:71], v[176:179], v[148:151], v[68:71]
    s_mov_b64 exec, s[84:85]
    ds_read_b128 v[172:175], v14 offset:8192
    s_mov_b64 exec, -1
    v_mfma_f32_16x16x32_bf16 v[72:75], v[176:179], v[152:155], v[72:75]
    buffer_load_dwordx4 v[224:227], v9, s[24:27], s68 offen offset:2048 sc1
    v_mfma_f32_16x16x32_bf16 v[76:79], v[180:183], v[136:139], v[76:79]
    v_add_u32 v14, s70, v14
    v_mfma_f32_16x16x32_bf16 v[80:83], v[180:183], v[140:143], v[80:83]
    s_mul_i32 s68, s91, 5120
    ds_read_b64_tr_b16 v[188:189], v17 offset:12288
    ds_read_b64_tr_b16 v[190:191], v17 offset:15360
    v_mfma_f32_16x16x32_bf16 v[84:87], v[180:183], v[144:147], v[84:87]
    s_setprio 0
    ds_read_b64_tr_b16 v[192:193], v18 offset:12288
    v_mfma_f32_16x16x32_bf16 v[88:91], v[180:183], v[148:151], v[88:91]
    ds_read_b64_tr_b16 v[194:195], v18 offset:15360
    v_mfma_f32_16x16x32_bf16 v[92:95], v[180:183], v[152:155], v[92:95]
    buffer_load_dwordx4 v[228:231], v9, s[24:27], s68 offen offset:3072 sc1
    v_add_u32 v17, s70, v17
    ds_read_b64_tr_b16 v[196:197], v19 offset:12288
    v_mfma_f32_16x16x32_bf16 v[96:99], v[184:187], v[136:139], v[96:99]
    ds_read_b64_tr_b16 v[198:199], v19 offset:15360
    v_mfma_f32_16x16x32_bf16 v[100:103], v[184:187], v[140:143], v[100:103]
    s_mov_b32 s71, s74
    v_add_u32 v18, s70, v18
    v_mfma_f32_16x16x32_bf16 v[104:107], v[184:187], v[144:147], v[104:107]
    v_add_u32 v19, s70, v19
    v_mfma_f32_16x16x32_bf16 v[108:111], v[184:187], v[148:151], v[108:111]
    v_add_u32 v13, s70, v13
    v_mfma_f32_16x16x32_bf16 v[112:115], v[184:187], v[152:155], v[112:115]
    s_waitcnt vmcnt(4) lgkmcnt(0)
    s_barrier
    s_setprio 3
    v_mfma_f32_16x16x32_bf16 v[56:59], v[188:191], v[156:159], v[56:59]
    v_add_u32 v7, 0, v21
    v_min_u32 v7, 4521952, v7
    ds_read_b128 v[136:139], v13 offset:0
    ds_read_b128 v[140:143], v13 offset:2048
    v_mfma_f32_16x16x32_bf16 v[60:63], v[188:191], v[160:163], v[60:63]
    buffer_load_dwordx4 v[28:31], v7, s[28:31], 0 offen sc1
    v_add_u32 v7, 512, v21
    ds_read_b128 v[144:147], v13 offset:4096
    v_mfma_f32_16x16x32_bf16 v[64:67], v[188:191], v[164:167], v[64:67]
    v_min_u32 v7, 4521952, v7
    ds_read_b128 v[148:151], v13 offset:6144
    v_mfma_f32_16x16x32_bf16 v[68:71], v[188:191], v[168:171], v[68:71]
    buffer_load_dwordx4 v[32:35], v7, s[28:31], 0 offen sc1
    v_add_u32 v7, 1024, v21
    s_mov_b64 exec, s[84:85]
    ds_read_b128 v[152:155], v13 offset:8192
    s_mov_b64 exec, -1
    v_mfma_f32_16x16x32_bf16 v[72:75], v[188:191], v[172:175], v[72:75]
    v_min_u32 v7, 4521952, v7
    v_mfma_f32_16x16x32_bf16 v[76:79], v[192:195], v[156:159], v[76:79]
    buffer_load_dwordx4 v[36:39], v7, s[28:31], 0 offen sc1
    v_add_u32 v7, 1536, v21
    v_mfma_f32_16x16x32_bf16 v[80:83], v[192:195], v[160:163], v[80:83]
    v_min_u32 v7, 4521952, v7
    ds_read_b64_tr_b16 v[176:177], v17 offset:0
    v_mfma_f32_16x16x32_bf16 v[84:87], v[192:195], v[164:167], v[84:87]
    buffer_load_dwordx4 v[40:43], v7, s[28:31], 0 offen sc1
    v_add_u32 v7, 2048, v21
    ds_read_b64_tr_b16 v[178:179], v17 offset:3072
    s_setprio 2
    v_mfma_f32_16x16x32_bf16 v[88:91], v[192:195], v[168:171], v[88:91]
    v_min_u32 v7, 4521952, v7
    ds_read_b64_tr_b16 v[180:181], v18 offset:0
    v_mfma_f32_16x16x32_bf16 v[92:95], v[192:195], v[172:175], v[92:95]
    buffer_load_dwordx4 v[44:47], v7, s[28:31], 0 offen sc1
    s_mul_i32 s68, s91, 5120
    ds_read_b64_tr_b16 v[182:183], v18 offset:3072
    v_mfma_f32_16x16x32_bf16 v[96:99], v[196:199], v[156:159], v[96:99]
    s_add_u32 s68, s68, 4096
    ds_read_b64_tr_b16 v[184:185], v19 offset:0
    v_mfma_f32_16x16x32_bf16 v[100:103], v[196:199], v[160:163], v[100:103]
    buffer_load_dwordx4 v[232:235], v9, s[24:27], s68 offen sc1
    s_mul_i32 s68, s92, 5120
    ds_read_b64_tr_b16 v[186:187], v19 offset:3072
    v_mfma_f32_16x16x32_bf16 v[104:107], v[196:199], v[164:167], v[104:107]
    buffer_load_dwordx4 v[236:239], v9, s[24:27], s68 offen offset:0 sc1
    v_mfma_f32_16x16x32_bf16 v[108:111], v[196:199], v[168:171], v[108:111]
    v_mfma_f32_16x16x32_bf16 v[112:115], v[196:199], v[172:175], v[112:115]
    s_add_u32 s65, s65, 1
    s_waitcnt lgkmcnt(0)
    v_mfma_f32_16x16x32_bf16 v[56:59], v[176:179], v[136:139], v[56:59]
    s_setprio 1
    ds_read_b128 v[156:159], v14 offset:0
    ds_read_b128 v[160:163], v14 offset:2048
    v_mfma_f32_16x16x32_bf16 v[60:63], v[176:179], v[140:143], v[60:63]
    ds_read_b128 v[164:167], v14 offset:4096
    v_mfma_f32_16x16x32_bf16 v[64:67], v[176:179], v[144:147], v[64:67]
    s_mul_i32 s68, s92, 5120
    ds_read_b128 v[168:171], v14 offset:6144
    v_mfma_f32_16x16x32_bf16 v[68:71], v[176:179], v[148:151], v[68:71]
    s_mov_b64 exec, s[84:85]
    ds_read_b128 v[172:175], v14 offset:8192
    s_mov_b64 exec, -1
    v_mfma_f32_16x16x32_bf16 v[72:75], v[176:179], v[152:155], v[72:75]
    v_mfma_f32_16x16x32_bf16 v[76:79], v[180:183], v[136:139], v[76:79]
    buffer_load_dwordx4 v[240:243], v9, s[24:27], s68 offen offset:1024 sc1
    v_mfma_f32_16x16x32_bf16 v[80:83], v[180:183], v[140:143], v[80:83]
    ds_read_b64_tr_b16 v[188:189], v17 offset:12288
    v_mfma_f32_16x16x32_bf16 v[84:87], v[180:183], v[144:147], v[84:87]
    s_setprio 0
    ds_read_b64_tr_b16 v[190:191], v17 offset:15360
    v_mfma_f32_16x16x32_bf16 v[88:91], v[180:183], v[148:151], v[88:91]
    s_mul_i32 s68, s92, 5120
    ds_read_b64_tr_b16 v[192:193], v18 offset:12288
    v_mfma_f32_16x16x32_bf16 v[92:95], v[180:183], v[152:155], v[92:95]
    ds_read_b64_tr_b16 v[194:195], v18 offset:15360
    v_mfma_f32_16x16x32_bf16 v[96:99], v[184:187], v[136:139], v[96:99]
    ds_read_b64_tr_b16 v[196:197], v19 offset:12288
    v_mfma_f32_16x16x32_bf16 v[100:103], v[184:187], v[140:143], v[100:103]
    buffer_load_dwordx4 v[244:247], v9, s[24:27], s68 offen offset:2048 sc1
    ds_read_b64_tr_b16 v[198:199], v19 offset:15360
    v_mfma_f32_16x16x32_bf16 v[104:107], v[184:187], v[144:147], v[104:107]
    v_mfma_f32_16x16x32_bf16 v[108:111], v[184:187], v[148:151], v[108:111]
    v_mfma_f32_16x16x32_bf16 v[112:115], v[184:187], v[152:155], v[112:115]
    s_waitcnt lgkmcnt(0)
    s_barrier
    s_setprio 3
    v_mfma_f32_16x16x32_bf16 v[56:59], v[188:191], v[156:159], v[56:59]
    s_mul_i32 s68, s92, 5120
    buffer_load_dwordx4 v[248:251], v9, s[24:27], s68 offen offset:3072 sc1
    v_mfma_f32_16x16x32_bf16 v[60:63], v[188:191], v[160:163], v[60:63]
    s_mul_i32 s68, s92, 5120
    v_mfma_f32_16x16x32_bf16 v[64:67], v[188:191], v[164:167], v[64:67]
    s_add_u32 s68, s68, 4096
    v_mfma_f32_16x16x32_bf16 v[68:71], v[188:191], v[168:171], v[68:71]
    buffer_load_dwordx4 v[252:255], v9, s[24:27], s68 offen sc1
    v_mfma_f32_16x16x32_bf16 v[72:75], v[188:191], v[172:175], v[72:75]
    v_lshlrev_b32 v7, 4, v2
    v_mfma_f32_16x16x32_bf16 v[76:79], v[192:195], v[156:159], v[76:79]
    s_lshl_b32 s73, s78, 6
    v_mfma_f32_16x16x32_bf16 v[80:83], v[192:195], v[160:163], v[80:83]
    s_add_u32 s73, s73, 88064
    v_add_u32 v17, s73, v7
    v_mfma_f32_16x16x32_bf16 v[84:87], v[192:195], v[164:167], v[84:87]
    s_lshl_b32 s73, s79, 6
    s_setprio 2
    v_mfma_f32_16x16x32_bf16 v[88:91], v[192:195], v[168:171], v[88:91]
    s_add_u32 s73, s73, 88064
    v_mfma_f32_16x16x32_bf16 v[92:95], v[192:195], v[172:175], v[92:95]
    v_add_u32 v18, s73, v7
    v_mfma_f32_16x16x32_bf16 v[96:99], v[196:199], v[156:159], v[96:99]
    s_lshl_b32 s73, s80, 6
    v_mfma_f32_16x16x32_bf16 v[100:103], v[196:199], v[160:163], v[100:103]
    s_add_u32 s73, s73, 88064
    v_mfma_f32_16x16x32_bf16 v[104:107], v[196:199], v[164:167], v[104:107]
    v_add_u32 v19, s73, v7
    v_mfma_f32_16x16x32_bf16 v[108:111], v[196:199], v[168:171], v[108:111]
    v_mfma_f32_16x16x32_bf16 v[112:115], v[196:199], v[172:175], v[112:115]
    s_setprio 0
    s_waitcnt vmcnt(6)
    s_mov_b32 s98, 0
    s_branch Lpo_57
Lpo_55:
    v_add_u32 v7, 0, v21
    v_min_u32 v7, 4521952, v7
    buffer_load_dwordx4 v[28:31], v7, s[28:31], 0 offen sc1
    v_add_u32 v7, 512, v21
    v_min_u32 v7, 4521952, v7
    buffer_load_dwordx4 v[32:35], v7, s[28:31], 0 offen sc1
    v_add_u32 v7, 1024, v21
    v_min_u32 v7, 4521952, v7
    buffer_load_dwordx4 v[36:39], v7, s[28:31], 0 offen sc1
    v_add_u32 v7, 1536, v21
    v_min_u32 v7, 4521952, v7
    buffer_load_dwordx4 v[40:43], v7, s[28:31], 0 offen sc1
    v_add_u32 v7, 2048, v21
    v_min_u32 v7, 4521952, v7
    buffer_load_dwordx4 v[44:47], v7, s[28:31], 0 offen sc1
    s_waitcnt vmcnt(0)
Lpo_57:
    v_cmp_eq_u64 vcc, s[82:83], v[30:31]
    v_cmp_eq_u64 s[74:75], s[82:83], v[34:35]
    s_nop 0
    s_and_b64 vcc, vcc, s[74:75]
    v_cmp_eq_u64 s[74:75], s[82:83], v[38:39]
    s_nop 0
    s_and_b64 vcc, vcc, s[74:75]
    v_cmp_eq_u64 s[74:75], s[82:83], v[42:43]
    s_nop 0
    s_and_b64 vcc, vcc, s[74:75]
    v_cmp_eq_u64 s[74:75], s[82:83], v[46:47]
    s_nop 0
    s_and_b64 vcc, vcc, s[74:75]
    s_add_u32 s98, s98, 1
    s_cmp_gt_u32 s98, 100000
    s_cbranch_scc1 Lpo_56
    s_cmp_eq_u64 vcc, -1
    s_cbranch_scc0 Lpo_55
Lpo_56:
    s_cmp_eq_u32 s77, 0
    s_cbranch_scc1 Lc_58
    s_not_b64 exec, s[84:85]
    ds_write_b128 v17, v[72:75]
    ds_write_b128 v18, v[92:95]
    ds_write_b128 v19, v[112:115]
    s_mov_b64 exec, -1
    s_waitcnt lgkmcnt(0)
Lc_58:
    s_barrier
    ds_read_b128 v[116:119], v17
    ds_read_b128 v[120:123], v18
    ds_read_b128 v[124:127], v19
    v_lshlrev_b32 v30, 16, v48
    v_and_b32 v31, 0xffff0000, v48
    v_lshlrev_b32 v34, 16, v49
    v_and_b32 v35, 0xffff0000, v49
    v_lshlrev_b32 v38, 16, v50
    v_and_b32 v39, 0xffff0000, v50
    v_lshlrev_b32 v42, 16, v51
    v_and_b32 v43, 0xffff0000, v51
    v_lshlrev_b32 v46, 16, v52
    v_and_b32 v47, 0xffff0000, v52
    v_lshlrev_b32 v52, 16, v53
    v_and_b32 v53, 0xffff0000, v53
    v_mov_b32 v24, 0xc0135761
    v_mov_b32 v25, 0xbdd2d3e8
    v_mov_b32 v26, 1.0
    v_and_b32 v6, 15, v15
    v_lshlrev_b32 v6, 4, v6
    v_lshl_add_u32 v5, v2, 8, v6
    v_and_b32 v7, 1, v2
    v_lshl_add_u32 v14, v7, 8, v6
    v_lshrrev_b32 v4, 4, v15
    v_lshrrev_b32 v7, 5, v1
    v_add_u32 v15, v4, v7
    s_mul_i32 s75, s64, 6
    s_add_u32 s75, s75, 20
    s_lshr_b32 s73, s78, 1
    s_add_u32 s73, s73, s75
    s_lshl_b32 s66, s73, 12
    s_lshr_b32 s73, s80, 1
    s_add_u32 s73, s73, s75
    s_lshl_b32 s67, s73, 12
    s_and_b32 s73, s80, 1
    s_lshl_b32 s73, s73, 9
    s_add_u32 s67, s67, s73
    s_mov_b32 s76, 303104
    s_waitcnt lgkmcnt(0)
    s_cmp_eq_u32 s77, 0
    s_cselect_b32 s84, -1, 0x00ff00ff
    s_mov_b32 s85, s84
    v_pk_fma_f32 v[128:129], v[116:117], v[28:29], v[30:31] op_sel:[0,1,0] op_sel_hi:[1,1,1]
    v_pk_fma_f32 v[130:131], v[118:119], v[28:29], v[34:35] op_sel:[0,1,0] op_sel_hi:[1,1,1]
    v_pk_fma_f32 v[132:133], v[120:121], v[28:29], v[38:39] op_sel:[0,1,0] op_sel_hi:[1,1,1]
    v_pk_fma_f32 v[134:135], v[122:123], v[28:29], v[42:43] op_sel:[0,1,0] op_sel_hi:[1,1,1]
    s_mul_i32 s68, s88, 5120
    buffer_load_dwordx4 v[156:159], v9, s[24:27], s68 offen offset:0 sc1
    v_pk_fma_f32 v[12:13], v[124:125], v[28:29], v[46:47] op_sel:[0,1,0] op_sel_hi:[1,1,1]
    v_pk_fma_f32 v[54:55], v[126:127], v[28:29], v[52:53] op_sel:[0,1,0] op_sel_hi:[1,1,1]
    v_pk_fma_f32 v[56:57], v[56:57], v[28:29], v[128:129] op_sel:[0,0,0] op_sel_hi:[1,0,1]
    v_pk_fma_f32 v[58:59], v[58:59], v[28:29], v[130:131] op_sel:[0,0,0] op_sel_hi:[1,0,1]
    v_pk_fma_f32 v[76:77], v[76:77], v[28:29], v[132:133] op_sel:[0,0,0] op_sel_hi:[1,0,1]
    v_pk_fma_f32 v[78:79], v[78:79], v[28:29], v[134:135] op_sel:[0,0,0] op_sel_hi:[1,0,1]
    v_pk_fma_f32 v[96:97], v[96:97], v[28:29], v[12:13] op_sel:[0,0,0] op_sel_hi:[1,0,1]
    v_pk_fma_f32 v[98:99], v[98:99], v[28:29], v[54:55] op_sel:[0,0,0] op_sel_hi:[1,0,1]
    v_pk_mul_f32 v[128:129], v[56:57], v[56:57]
    v_pk_mul_f32 v[130:131], v[58:59], v[58:59]
    v_pk_mul_f32 v[132:133], v[76:77], v[76:77]
    v_pk_mul_f32 v[134:135], v[78:79], v[78:79]
    v_pk_mul_f32 v[12:13], v[96:97], v[96:97]
    v_pk_mul_f32 v[54:55], v[98:99], v[98:99]
    v_pk_fma_f32 v[128:129], v[128:129], v[24:25], v[24:25] op_sel:[0,1,0] op_sel_hi:[1,1,0]
    v_pk_fma_f32 v[130:131], v[130:131], v[24:25], v[24:25] op_sel:[0,1,0] op_sel_hi:[1,1,0]
    v_pk_fma_f32 v[132:133], v[132:133], v[24:25], v[24:25] op_sel:[0,1,0] op_sel_hi:[1,1,0]
    v_pk_fma_f32 v[134:135], v[134:135], v[24:25], v[24:25] op_sel:[0,1,0] op_sel_hi:[1,1,0]
    v_pk_fma_f32 v[12:13], v[12:13], v[24:25], v[24:25] op_sel:[0,1,0] op_sel_hi:[1,1,0]
    v_pk_fma_f32 v[54:55], v[54:55], v[24:25], v[24:25] op_sel:[0,1,0] op_sel_hi:[1,1,0]
    v_pk_mul_f32 v[128:129], v[128:129], v[56:57]
    v_pk_mul_f32 v[130:131], v[130:131], v[58:59]
    v_pk_mul_f32 v[132:133], v[132:133], v[76:77]
    v_pk_mul_f32 v[134:135], v[134:135], v[78:79]
    v_pk_mul_f32 v[12:13], v[12:13], v[96:97]
    v_pk_mul_f32 v[54:55], v[54:55], v[98:99]
    v_exp_f32 v128, v128
    v_exp_f32 v130, v130
    v_exp_f32 v132, v132
    v_exp_f32 v134, v134
    v_exp_f32 v12, v12
    v_exp_f32 v54, v54
    v_exp_f32 v129, v129
    v_exp_f32 v131, v131
    v_exp_f32 v133, v133
    v_exp_f32 v135, v135
    v_exp_f32 v13, v13
    v_exp_f32 v55, v55
    v_pk_add_f32 v[128:129], v[128:129], v[26:27] op_sel_hi:[1,0]
    v_pk_add_f32 v[130:131], v[130:131], v[26:27] op_sel_hi:[1,0]
    s_mul_i32 s68, s88, 5120
    buffer_load_dwordx4 v[160:163], v9, s[24:27], s68 offen offset:1024 sc1
    v_pk_add_f32 v[132:133], v[132:133], v[26:27] op_sel_hi:[1,0]
    v_pk_add_f32 v[134:135], v[134:135], v[26:27] op_sel_hi:[1,0]
    v_pk_add_f32 v[12:13], v[12:13], v[26:27] op_sel_hi:[1,0]
    v_pk_add_f32 v[54:55], v[54:55], v[26:27] op_sel_hi:[1,0]
    v_rcp_f32 v128, v128
    v_rcp_f32 v130, v130
    v_rcp_f32 v132, v132
    v_rcp_f32 v134, v134
    v_rcp_f32 v12, v12
    v_rcp_f32 v54, v54
    v_rcp_f32 v129, v129
    v_rcp_f32 v131, v131
    v_rcp_f32 v133, v133
    v_rcp_f32 v135, v135
    v_rcp_f32 v13, v13
    v_rcp_f32 v55, v55
    v_pk_mul_f32 v[128:129], v[128:129], v[56:57]
    v_pk_mul_f32 v[130:131], v[130:131], v[58:59]
    v_pk_mul_f32 v[132:133], v[132:133], v[76:77]
    v_pk_mul_f32 v[134:135], v[134:135], v[78:79]
    v_pk_mul_f32 v[12:13], v[12:13], v[96:97]
    v_pk_mul_f32 v[54:55], v[54:55], v[98:99]
    v_cvt_pk_bf16_f32 v56, v128, v129
    v_cvt_pk_bf16_f32 v57, v130, v131
    v_cvt_pk_bf16_f32 v58, v132, v133
    v_cvt_pk_bf16_f32 v59, v134, v135
    v_cvt_pk_bf16_f32 v96, v12, v13
    v_cvt_pk_bf16_f32 v97, v54, v55
    v_lshrrev_b32 v6, 2, v4
    v_mul_u32_u24 v6, s76, v6
    v_and_b32 v7, 3, v4
    v_lshl_add_u32 v6, v7, 10, v6
    v_add_u32 v76, v6, v5
    v_add_u32 v4, 1, v4
    buffer_store_dwordx4 v[56:59], v76, s[16:19], s66 offen sc1
    v_pk_fma_f32 v[128:129], v[116:117], v[32:33], v[30:31] op_sel:[0,1,0] op_sel_hi:[1,1,1]
    v_pk_fma_f32 v[130:131], v[118:119], v[32:33], v[34:35] op_sel:[0,1,0] op_sel_hi:[1,1,1]
    v_pk_fma_f32 v[132:133], v[120:121], v[32:33], v[38:39] op_sel:[0,1,0] op_sel_hi:[1,1,1]
    v_pk_fma_f32 v[134:135], v[122:123], v[32:33], v[42:43] op_sel:[0,1,0] op_sel_hi:[1,1,1]
    v_pk_fma_f32 v[12:13], v[124:125], v[32:33], v[46:47] op_sel:[0,1,0] op_sel_hi:[1,1,1]
    v_pk_fma_f32 v[54:55], v[126:127], v[32:33], v[52:53] op_sel:[0,1,0] op_sel_hi:[1,1,1]
    s_mul_i32 s68, s88, 5120
    buffer_load_dwordx4 v[164:167], v9, s[24:27], s68 offen offset:2048 sc1
    v_pk_fma_f32 v[60:61], v[60:61], v[32:33], v[128:129] op_sel:[0,0,0] op_sel_hi:[1,0,1]
    v_pk_fma_f32 v[62:63], v[62:63], v[32:33], v[130:131] op_sel:[0,0,0] op_sel_hi:[1,0,1]
    v_pk_fma_f32 v[80:81], v[80:81], v[32:33], v[132:133] op_sel:[0,0,0] op_sel_hi:[1,0,1]
    v_pk_fma_f32 v[82:83], v[82:83], v[32:33], v[134:135] op_sel:[0,0,0] op_sel_hi:[1,0,1]
    v_pk_fma_f32 v[100:101], v[100:101], v[32:33], v[12:13] op_sel:[0,0,0] op_sel_hi:[1,0,1]
    v_pk_fma_f32 v[102:103], v[102:103], v[32:33], v[54:55] op_sel:[0,0,0] op_sel_hi:[1,0,1]
    v_pk_mul_f32 v[128:129], v[60:61], v[60:61]
    v_pk_mul_f32 v[130:131], v[62:63], v[62:63]
    v_pk_mul_f32 v[132:133], v[80:81], v[80:81]
    v_pk_mul_f32 v[134:135], v[82:83], v[82:83]
    v_pk_mul_f32 v[12:13], v[100:101], v[100:101]
    v_pk_mul_f32 v[54:55], v[102:103], v[102:103]
    v_pk_fma_f32 v[128:129], v[128:129], v[24:25], v[24:25] op_sel:[0,1,0] op_sel_hi:[1,1,0]
    v_pk_fma_f32 v[130:131], v[130:131], v[24:25], v[24:25] op_sel:[0,1,0] op_sel_hi:[1,1,0]
    v_pk_fma_f32 v[132:133], v[132:133], v[24:25], v[24:25] op_sel:[0,1,0] op_sel_hi:[1,1,0]
    v_pk_fma_f32 v[134:135], v[134:135], v[24:25], v[24:25] op_sel:[0,1,0] op_sel_hi:[1,1,0]
    v_pk_fma_f32 v[12:13], v[12:13], v[24:25], v[24:25] op_sel:[0,1,0] op_sel_hi:[1,1,0]
    v_pk_fma_f32 v[54:55], v[54:55], v[24:25], v[24:25] op_sel:[0,1,0] op_sel_hi:[1,1,0]
    v_pk_mul_f32 v[128:129], v[128:129], v[60:61]
    v_pk_mul_f32 v[130:131], v[130:131], v[62:63]
    v_pk_mul_f32 v[132:133], v[132:133], v[80:81]
    v_pk_mul_f32 v[134:135], v[134:135], v[82:83]
    v_pk_mul_f32 v[12:13], v[12:13], v[100:101]
    v_pk_mul_f32 v[54:55], v[54:55], v[102:103]
    v_exp_f32 v128, v128
    v_exp_f32 v130, v130
    v_exp_f32 v132, v132
    v_exp_f32 v134, v134
    v_exp_f32 v12, v12
    v_exp_f32 v54, v54
    v_exp_f32 v129, v129
    v_exp_f32 v131, v131
    v_exp_f32 v133, v133
    v_exp_f32 v135, v135
    v_exp_f32 v13, v13
    v_exp_f32 v55, v55
    v_pk_add_f32 v[128:129], v[128:129], v[26:27] op_sel_hi:[1,0]
    v_pk_add_f32 v[130:131], v[130:131], v[26:27] op_sel_hi:[1,0]
    v_pk_add_f32 v[132:133], v[132:133], v[26:27] op_sel_hi:[1,0]
    v_pk_add_f32 v[134:135], v[134:135], v[26:27] op_sel_hi:[1,0]
    s_mul_i32 s68, s88, 5120
    buffer_load_dwordx4 v[168:171], v9, s[24:27], s68 offen offset:3072 sc1
    v_pk_add_f32 v[12:13], v[12:13], v[26:27] op_sel_hi:[1,0]
    v_pk_add_f32 v[54:55], v[54:55], v[26:27] op_sel_hi:[1,0]
    v_rcp_f32 v128, v128
    v_rcp_f32 v130, v130
    v_rcp_f32 v132, v132
    v_rcp_f32 v134, v134
    v_rcp_f32 v12, v12
    v_rcp_f32 v54, v54
    v_rcp_f32 v129, v129
    v_rcp_f32 v131, v131
    v_rcp_f32 v133, v133
    v_rcp_f32 v135, v135
    v_rcp_f32 v13, v13
    v_rcp_f32 v55, v55
    v_pk_mul_f32 v[128:129], v[128:129], v[60:61]
    v_pk_mul_f32 v[130:131], v[130:131], v[62:63]
    v_pk_mul_f32 v[132:133], v[132:133], v[80:81]
    v_pk_mul_f32 v[134:135], v[134:135], v[82:83]
    v_pk_mul_f32 v[12:13], v[12:13], v[100:101]
    v_pk_mul_f32 v[54:55], v[54:55], v[102:103]
    v_cvt_pk_bf16_f32 v60, v128, v129
    v_cvt_pk_bf16_f32 v61, v130, v131
    v_cvt_pk_bf16_f32 v62, v132, v133
    v_cvt_pk_bf16_f32 v63, v134, v135
    v_cvt_pk_bf16_f32 v98, v12, v13
    v_cvt_pk_bf16_f32 v99, v54, v55
    v_lshrrev_b32 v6, 2, v4
    v_mul_u32_u24 v6, s76, v6
    v_and_b32 v7, 3, v4
    v_lshl_add_u32 v6, v7, 10, v6
    v_add_u32 v80, v6, v5
    v_add_u32 v4, 1, v4
    v_permlane32_swap_b32 v96, v98
    v_permlane32_swap_b32 v97, v99
    v_lshrrev_b32 v6, 2, v15
    v_mul_u32_u24 v6, s76, v6
    v_and_b32 v7, 3, v15
    v_lshl_add_u32 v6, v7, 10, v6
    v_add_u32 v81, v6, v14
    v_add_u32 v15, 2, v15
    buffer_store_dwordx4 v[60:63], v80, s[16:19], s66 offen sc1
    buffer_store_dwordx4 v[96:99], v81, s[16:19], s67 offen sc1
    v_pk_fma_f32 v[128:129], v[116:117], v[36:37], v[30:31] op_sel:[0,1,0] op_sel_hi:[1,1,1]
    v_pk_fma_f32 v[130:131], v[118:119], v[36:37], v[34:35] op_sel:[0,1,0] op_sel_hi:[1,1,1]
    s_mul_i32 s68, s88, 5120
    s_add_u32 s68, s68, 4096
    buffer_load_dwordx4 v[172:175], v9, s[24:27], s68 offen sc1
    v_pk_fma_f32 v[132:133], v[120:121], v[36:37], v[38:39] op_sel:[0,1,0] op_sel_hi:[1,1,1]
    v_pk_fma_f32 v[134:135], v[122:123], v[36:37], v[42:43] op_sel:[0,1,0] op_sel_hi:[1,1,1]
    v_pk_fma_f32 v[12:13], v[124:125], v[36:37], v[46:47] op_sel:[0,1,0] op_sel_hi:[1,1,1]
    v_pk_fma_f32 v[54:55], v[126:127], v[36:37], v[52:53] op_sel:[0,1,0] op_sel_hi:[1,1,1]
    v_pk_fma_f32 v[64:65], v[64:65], v[36:37], v[128:129] op_sel:[0,0,0] op_sel_hi:[1,0,1]
    v_pk_fma_f32 v[66:67], v[66:67], v[36:37], v[130:131] op_sel:[0,0,0] op_sel_hi:[1,0,1]
    v_pk_fma_f32 v[84:85], v[84:85], v[36:37], v[132:133] op_sel:[0,0,0] op_sel_hi:[1,0,1]
    v_pk_fma_f32 v[86:87], v[86:87], v[36:37], v[134:135] op_sel:[0,0,0] op_sel_hi:[1,0,1]
    v_pk_fma_f32 v[104:105], v[104:105], v[36:37], v[12:13] op_sel:[0,0,0] op_sel_hi:[1,0,1]
    v_pk_fma_f32 v[106:107], v[106:107], v[36:37], v[54:55] op_sel:[0,0,0] op_sel_hi:[1,0,1]
    v_pk_mul_f32 v[128:129], v[64:65], v[64:65]
    v_pk_mul_f32 v[130:131], v[66:67], v[66:67]
    v_pk_mul_f32 v[132:133], v[84:85], v[84:85]
    v_pk_mul_f32 v[134:135], v[86:87], v[86:87]
    v_pk_mul_f32 v[12:13], v[104:105], v[104:105]
    v_pk_mul_f32 v[54:55], v[106:107], v[106:107]
    v_pk_fma_f32 v[128:129], v[128:129], v[24:25], v[24:25] op_sel:[0,1,0] op_sel_hi:[1,1,0]
    v_pk_fma_f32 v[130:131], v[130:131], v[24:25], v[24:25] op_sel:[0,1,0] op_sel_hi:[1,1,0]
    v_pk_fma_f32 v[132:133], v[132:133], v[24:25], v[24:25] op_sel:[0,1,0] op_sel_hi:[1,1,0]
    v_pk_fma_f32 v[134:135], v[134:135], v[24:25], v[24:25] op_sel:[0,1,0] op_sel_hi:[1,1,0]
    v_pk_fma_f32 v[12:13], v[12:13], v[24:25], v[24:25] op_sel:[0,1,0] op_sel_hi:[1,1,0]
    v_pk_fma_f32 v[54:55], v[54:55], v[24:25], v[24:25] op_sel:[0,1,0] op_sel_hi:[1,1,0]
    v_pk_mul_f32 v[128:129], v[128:129], v[64:65]
    v_pk_mul_f32 v[130:131], v[130:131], v[66:67]
    v_pk_mul_f32 v[132:133], v[132:133], v[84:85]
    v_pk_mul_f32 v[134:135], v[134:135], v[86:87]
    v_pk_mul_f32 v[12:13], v[12:13], v[104:105]
    v_pk_mul_f32 v[54:55], v[54:55], v[106:107]
    v_exp_f32 v128, v128
    v_exp_f32 v130, v130
    v_exp_f32 v132, v132
    v_exp_f32 v134, v134
    v_exp_f32 v12, v12
    v_exp_f32 v54, v54
    v_exp_f32 v129, v129
    v_exp_f32 v131, v131
    v_exp_f32 v133, v133
    v_exp_f32 v135, v135
    v_exp_f32 v13, v13
    v_exp_f32 v55, v55
    s_mul_i32 s68, s89, 5120
    buffer_load_dwordx4 v[176:179], v9, s[24:27], s68 offen offset:0 sc1
    v_pk_add_f32 v[128:129], v[128:129], v[26:27] op_sel_hi:[1,0]
    v_pk_add_f32 v[130:131], v[130:131], v[26:27] op_sel_hi:[1,0]
    v_pk_add_f32 v[132:133], v[132:133], v[26:27] op_sel_hi:[1,0]
    v_pk_add_f32 v[134:135], v[134:135], v[26:27] op_sel_hi:[1,0]
    v_pk_add_f32 v[12:13], v[12:13], v[26:27] op_sel_hi:[1,0]
    v_pk_add_f32 v[54:55], v[54:55], v[26:27] op_sel_hi:[1,0]
    v_rcp_f32 v128, v128
    v_rcp_f32 v130, v130
    v_rcp_f32 v132, v132
    v_rcp_f32 v134, v134
    v_rcp_f32 v12, v12
    v_rcp_f32 v54, v54
    v_rcp_f32 v129, v129
    v_rcp_f32 v131, v131
    v_rcp_f32 v133, v133
    v_rcp_f32 v135, v135
    v_rcp_f32 v13, v13
    v_rcp_f32 v55, v55
    v_pk_mul_f32 v[128:129], v[128:129], v[64:65]
    v_pk_mul_f32 v[130:131], v[130:131], v[66:67]
    v_pk_mul_f32 v[132:133], v[132:133], v[84:85]
    v_pk_mul_f32 v[134:135], v[134:135], v[86:87]
    v_pk_mul_f32 v[12:13], v[12:13], v[104:105]
    v_pk_mul_f32 v[54:55], v[54:55], v[106:107]
    v_cvt_pk_bf16_f32 v64, v128, v129
    v_cvt_pk_bf16_f32 v65, v130, v131
    v_cvt_pk_bf16_f32 v66, v132, v133
    v_cvt_pk_bf16_f32 v67, v134, v135
    v_cvt_pk_bf16_f32 v104, v12, v13
    v_cvt_pk_bf16_f32 v105, v54, v55
    v_lshrrev_b32 v6, 2, v4
    v_mul_u32_u24 v6, s76, v6
    v_and_b32 v7, 3, v4
    v_lshl_add_u32 v6, v7, 10, v6
    v_add_u32 v84, v6, v5
    v_add_u32 v4, 1, v4
    buffer_store_dwordx4 v[64:67], v84, s[16:19], s66 offen sc1
    v_pk_fma_f32 v[128:129], v[116:117], v[40:41], v[30:31] op_sel:[0,1,0] op_sel_hi:[1,1,1]
    v_pk_fma_f32 v[130:131], v[118:119], v[40:41], v[34:35] op_sel:[0,1,0] op_sel_hi:[1,1,1]
    v_pk_fma_f32 v[132:133], v[120:121], v[40:41], v[38:39] op_sel:[0,1,0] op_sel_hi:[1,1,1]
    v_pk_fma_f32 v[134:135], v[122:123], v[40:41], v[42:43] op_sel:[0,1,0] op_sel_hi:[1,1,1]
    s_mul_i32 s68, s89, 5120
    buffer_load_dwordx4 v[180:183], v9, s[24:27], s68 offen offset:1024 sc1
    v_pk_fma_f32 v[12:13], v[124:125], v[40:41], v[46:47] op_sel:[0,1,0] op_sel_hi:[1,1,1]
    v_pk_fma_f32 v[54:55], v[126:127], v[40:41], v[52:53] op_sel:[0,1,0] op_sel_hi:[1,1,1]
    v_pk_fma_f32 v[68:69], v[68:69], v[40:41], v[128:129] op_sel:[0,0,0] op_sel_hi:[1,0,1]
    v_pk_fma_f32 v[70:71], v[70:71], v[40:41], v[130:131] op_sel:[0,0,0] op_sel_hi:[1,0,1]
    v_pk_fma_f32 v[88:89], v[88:89], v[40:41], v[132:133] op_sel:[0,0,0] op_sel_hi:[1,0,1]
    v_pk_fma_f32 v[90:91], v[90:91], v[40:41], v[134:135] op_sel:[0,0,0] op_sel_hi:[1,0,1]
    v_pk_fma_f32 v[108:109], v[108:109], v[40:41], v[12:13] op_sel:[0,0,0] op_sel_hi:[1,0,1]
    v_pk_fma_f32 v[110:111], v[110:111], v[40:41], v[54:55] op_sel:[0,0,0] op_sel_hi:[1,0,1]
    v_pk_mul_f32 v[128:129], v[68:69], v[68:69]
    v_pk_mul_f32 v[130:131], v[70:71], v[70:71]
    v_pk_mul_f32 v[132:133], v[88:89], v[88:89]
    v_pk_mul_f32 v[134:135], v[90:91], v[90:91]
    v_pk_mul_f32 v[12:13], v[108:109], v[108:109]
    v_pk_mul_f32 v[54:55], v[110:111], v[110:111]
    v_pk_fma_f32 v[128:129], v[128:129], v[24:25], v[24:25] op_sel:[0,1,0] op_sel_hi:[1,1,0]
    v_pk_fma_f32 v[130:131], v[130:131], v[24:25], v[24:25] op_sel:[0,1,0] op_sel_hi:[1,1,0]
    v_pk_fma_f32 v[132:133], v[132:133], v[24:25], v[24:25] op_sel:[0,1,0] op_sel_hi:[1,1,0]
    v_pk_fma_f32 v[134:135], v[134:135], v[24:25], v[24:25] op_sel:[0,1,0] op_sel_hi:[1,1,0]
    v_pk_fma_f32 v[12:13], v[12:13], v[24:25], v[24:25] op_sel:[0,1,0] op_sel_hi:[1,1,0]
    v_pk_fma_f32 v[54:55], v[54:55], v[24:25], v[24:25] op_sel:[0,1,0] op_sel_hi:[1,1,0]
    v_pk_mul_f32 v[128:129], v[128:129], v[68:69]
    v_pk_mul_f32 v[130:131], v[130:131], v[70:71]
    v_pk_mul_f32 v[132:133], v[132:133], v[88:89]
    v_pk_mul_f32 v[134:135], v[134:135], v[90:91]
    v_pk_mul_f32 v[12:13], v[12:13], v[108:109]
    v_pk_mul_f32 v[54:55], v[54:55], v[110:111]
    v_exp_f32 v128, v128
    v_exp_f32 v130, v130
    v_exp_f32 v132, v132
    v_exp_f32 v134, v134
    v_exp_f32 v12, v12
    v_exp_f32 v54, v54
    v_exp_f32 v129, v129
    v_exp_f32 v131, v131
    v_exp_f32 v133, v133
    v_exp_f32 v135, v135
    v_exp_f32 v13, v13
    v_exp_f32 v55, v55
    v_pk_add_f32 v[128:129], v[128:129], v[26:27] op_sel_hi:[1,0]
    v_pk_add_f32 v[130:131], v[130:131], v[26:27] op_sel_hi:[1,0]
    s_mul_i32 s68, s89, 5120
    buffer_load_dwordx4 v[184:187], v9, s[24:27], s68 offen offset:2048 sc1
    v_pk_add_f32 v[132:133], v[132:133], v[26:27] op_sel_hi:[1,0]
    v_pk_add_f32 v[134:135], v[134:135], v[26:27] op_sel_hi:[1,0]
    v_pk_add_f32 v[12:13], v[12:13], v[26:27] op_sel_hi:[1,0]
    v_pk_add_f32 v[54:55], v[54:55], v[26:27] op_sel_hi:[1,0]
    v_rcp_f32 v128, v128
    v_rcp_f32 v130, v130
    v_rcp_f32 v132, v132
    v_rcp_f32 v134, v134
    v_rcp_f32 v12, v12
    v_rcp_f32 v54, v54
    v_rcp_f32 v129, v129
    v_rcp_f32 v131, v131
    v_rcp_f32 v133, v133
    v_rcp_f32 v135, v135
    v_rcp_f32 v13, v13
    v_rcp_f32 v55, v55
    v_pk_mul_f32 v[128:129], v[128:129], v[68:69]
    v_pk_mul_f32 v[130:131], v[130:131], v[70:71]
    v_pk_mul_f32 v[132:133], v[132:133], v[88:89]
    v_pk_mul_f32 v[134:135], v[134:135], v[90:91]
    v_pk_mul_f32 v[12:13], v[12:13], v[108:109]
    v_pk_mul_f32 v[54:55], v[54:55], v[110:111]
    v_cvt_pk_bf16_f32 v68, v128, v129
    v_cvt_pk_bf16_f32 v69, v130, v131
    v_cvt_pk_bf16_f32 v70, v132, v133
    v_cvt_pk_bf16_f32 v71, v134, v135
    v_cvt_pk_bf16_f32 v106, v12, v13
    v_cvt_pk_bf16_f32 v107, v54, v55
    v_lshrrev_b32 v6, 2, v4
    v_mul_u32_u24 v6, s76, v6
    v_and_b32 v7, 3, v4
    v_lshl_add_u32 v6, v7, 10, v6
    v_add_u32 v88, v6, v5
    v_add_u32 v4, 1, v4
    v_permlane32_swap_b32 v104, v106
    v_permlane32_swap_b32 v105, v107
    v_lshrrev_b32 v6, 2, v15
    v_mul_u32_u24 v6, s76, v6
    v_and_b32 v7, 3, v15
    v_lshl_add_u32 v6, v7, 10, v6
    v_add_u32 v89, v6, v14
    v_add_u32 v15, 2, v15
    s_mul_i32 s68, s89, 5120
    buffer_load_dwordx4 v[188:191], v9, s[24:27], s68 offen offset:3072 sc1
    buffer_store_dwordx4 v[68:71], v88, s[16:19], s66 offen sc1
    buffer_store_dwordx4 v[104:107], v89, s[16:19], s67 offen sc1
    v_pk_fma_f32 v[128:129], v[116:117], v[44:45], v[30:31] op_sel:[0,1,0] op_sel_hi:[1,1,1]
    v_pk_fma_f32 v[130:131], v[118:119], v[44:45], v[34:35] op_sel:[0,1,0] op_sel_hi:[1,1,1]
    v_pk_fma_f32 v[132:133], v[120:121], v[44:45], v[38:39] op_sel:[0,1,0] op_sel_hi:[1,1,1]
    v_pk_fma_f32 v[134:135], v[122:123], v[44:45], v[42:43] op_sel:[0,1,0] op_sel_hi:[1,1,1]
    v_pk_fma_f32 v[12:13], v[124:125], v[44:45], v[46:47] op_sel:[0,1,0] op_sel_hi:[1,1,1]
    v_pk_fma_f32 v[54:55], v[126:127], v[44:45], v[52:53] op_sel:[0,1,0] op_sel_hi:[1,1,1]
    v_pk_fma_f32 v[72:73], v[72:73], v[44:45], v[128:129] op_sel:[0,0,0] op_sel_hi:[1,0,1]
    v_pk_fma_f32 v[74:75], v[74:75], v[44:45], v[130:131] op_sel:[0,0,0] op_sel_hi:[1,0,1]
    v_pk_fma_f32 v[92:93], v[92:93], v[44:45], v[132:133] op_sel:[0,0,0] op_sel_hi:[1,0,1]
    v_pk_fma_f32 v[94:95], v[94:95], v[44:45], v[134:135] op_sel:[0,0,0] op_sel_hi:[1,0,1]
    v_pk_fma_f32 v[112:113], v[112:113], v[44:45], v[12:13] op_sel:[0,0,0] op_sel_hi:[1,0,1]
    v_pk_fma_f32 v[114:115], v[114:115], v[44:45], v[54:55] op_sel:[0,0,0] op_sel_hi:[1,0,1]
    v_pk_mul_f32 v[128:129], v[72:73], v[72:73]
    v_pk_mul_f32 v[130:131], v[74:75], v[74:75]
    v_pk_mul_f32 v[132:133], v[92:93], v[92:93]
    v_pk_mul_f32 v[134:135], v[94:95], v[94:95]
    v_pk_mul_f32 v[12:13], v[112:113], v[112:113]
    v_pk_mul_f32 v[54:55], v[114:115], v[114:115]
    v_pk_fma_f32 v[128:129], v[128:129], v[24:25], v[24:25] op_sel:[0,1,0] op_sel_hi:[1,1,0]
    v_pk_fma_f32 v[130:131], v[130:131], v[24:25], v[24:25] op_sel:[0,1,0] op_sel_hi:[1,1,0]
    v_pk_fma_f32 v[132:133], v[132:133], v[24:25], v[24:25] op_sel:[0,1,0] op_sel_hi:[1,1,0]
    v_pk_fma_f32 v[134:135], v[134:135], v[24:25], v[24:25] op_sel:[0,1,0] op_sel_hi:[1,1,0]
    v_pk_fma_f32 v[12:13], v[12:13], v[24:25], v[24:25] op_sel:[0,1,0] op_sel_hi:[1,1,0]
    v_pk_fma_f32 v[54:55], v[54:55], v[24:25], v[24:25] op_sel:[0,1,0] op_sel_hi:[1,1,0]
    v_pk_mul_f32 v[128:129], v[128:129], v[72:73]
    v_pk_mul_f32 v[130:131], v[130:131], v[74:75]
    v_pk_mul_f32 v[132:133], v[132:133], v[92:93]
    v_pk_mul_f32 v[134:135], v[134:135], v[94:95]
    v_pk_mul_f32 v[12:13], v[12:13], v[112:113]
    v_pk_mul_f32 v[54:55], v[54:55], v[114:115]
    v_exp_f32 v128, v128
    v_exp_f32 v130, v130
    v_exp_f32 v132, v132
    v_exp_f32 v134, v134
    v_exp_f32 v12, v12
    v_exp_f32 v54, v54
    v_exp_f32 v129, v129
    v_exp_f32 v131, v131
    v_exp_f32 v133, v133
    v_exp_f32 v135, v135
    s_mul_i32 s68, s89, 5120
    s_add_u32 s68, s68, 4096
    buffer_load_dwordx4 v[192:195], v9, s[24:27], s68 offen sc1
    v_exp_f32 v13, v13
    v_exp_f32 v55, v55
    v_pk_add_f32 v[128:129], v[128:129], v[26:27] op_sel_hi:[1,0]
    v_pk_add_f32 v[130:131], v[130:131], v[26:27] op_sel_hi:[1,0]
    v_pk_add_f32 v[132:133], v[132:133], v[26:27] op_sel_hi:[1,0]
    v_pk_add_f32 v[134:135], v[134:135], v[26:27] op_sel_hi:[1,0]
    v_pk_add_f32 v[12:13], v[12:13], v[26:27] op_sel_hi:[1,0]
    v_pk_add_f32 v[54:55], v[54:55], v[26:27] op_sel_hi:[1,0]
    v_rcp_f32 v128, v128
    v_rcp_f32 v130, v130
    v_rcp_f32 v132, v132
    v_rcp_f32 v134, v134
    v_rcp_f32 v12, v12
    v_rcp_f32 v54, v54
    v_rcp_f32 v129, v129
    v_rcp_f32 v131, v131
    v_rcp_f32 v133, v133
    v_rcp_f32 v135, v135
    v_rcp_f32 v13, v13
    v_rcp_f32 v55, v55
    v_pk_mul_f32 v[128:129], v[128:129], v[72:73]
    v_pk_mul_f32 v[130:131], v[130:131], v[74:75]
    v_pk_mul_f32 v[132:133], v[132:133], v[92:93]
    v_pk_mul_f32 v[134:135], v[134:135], v[94:95]
    v_pk_mul_f32 v[12:13], v[12:13], v[112:113]
    v_pk_mul_f32 v[54:55], v[54:55], v[114:115]
    v_cvt_pk_bf16_f32 v72, v128, v129
    v_cvt_pk_bf16_f32 v73, v130, v131
    v_cvt_pk_bf16_f32 v74, v132, v133
    v_cvt_pk_bf16_f32 v75, v134, v135
    v_cvt_pk_bf16_f32 v112, v12, v13
    v_cvt_pk_bf16_f32 v113, v54, v55
    v_lshrrev_b32 v6, 2, v4
    v_mul_u32_u24 v6, s76, v6
    v_and_b32 v7, 3, v4
    v_lshl_add_u32 v6, v7, 10, v6
    v_add_u32 v92, v6, v5
    v_add_u32 v4, 1, v4
    v_permlane32_swap_b32 v112, v114
    v_permlane32_swap_b32 v113, v115
    v_lshrrev_b32 v6, 2, v15
    v_mul_u32_u24 v6, s76, v6
    s_mul_i32 s68, s90, 5120
    buffer_load_dwordx4 v[196:199], v9, s[24:27], s68 offen offset:0 sc1
    v_and_b32 v7, 3, v15
    v_lshl_add_u32 v6, v7, 10, v6
    v_add_u32 v93, v6, v14
    v_add_u32 v15, 2, v15
    s_mov_b64 exec, s[84:85]
    buffer_store_dwordx4 v[72:75], v92, s[16:19], s66 offen sc1
    s_mov_b64 exec, -1
    s_mov_b32 exec_lo, s84
    s_mov_b32 exec_hi, 0
    buffer_store_dwordx4 v[112:115], v93, s[16:19], s67 offen sc1
    s_mov_b64 exec, -1
    s_waitcnt vmcnt(0)
Lp_60:
    s_barrier
    s_cmp_lg_u32 s62, 0
    s_cbranch_scc1 Lp_59
    v_mov_b32 v4, s82
    v_mov_b32 v5, s83
    v_lshlrev_b32 v6, 3, v1
    s_lshl_b32 s43, s43, 4
    s_add_u32 s43, s43, 4325376
    s_mov_b64 exec, 65535
    buffer_store_dwordx2 v[4:5], v6, s[28:31], s43 offen sc1
    s_mov_b64 exec, -1
Lp_59:
    s_mul_i32 s68, s90, 5120
    buffer_load_dwordx4 v[200:203], v9, s[24:27], s68 offen offset:1024 sc1
    s_mul_i32 s68, s90, 5120
    buffer_load_dwordx4 v[204:207], v9, s[24:27], s68 offen offset:2048 sc1
    s_mul_i32 s68, s90, 5120
    buffer_load_dwordx4 v[208:211], v9, s[24:27], s68 offen offset:3072 sc1
    s_mul_i32 s68, s90, 5120
    s_add_u32 s68, s68, 4096
    buffer_load_dwordx4 v[212:215], v9, s[24:27], s68 offen sc1
    s_add_u32 m0, s69, 0
    s_mul_i32 s68, s93, 5120
    s_add_u32 s68, s68, 0
    buffer_load_dwordx4 v9, s[24:27], s68 offen sc1 lds
    s_add_u32 m0, s69, 1024
    s_mul_i32 s68, s93, 5120
    s_add_u32 s68, s68, 1024
    buffer_load_dwordx4 v9, s[24:27], s68 offen sc1 lds
    s_add_u32 m0, s69, 2048
    s_mul_i32 s68, s93, 5120
    s_add_u32 s68, s68, 2048
    buffer_load_dwordx4 v9, s[24:27], s68 offen sc1 lds
    s_add_u32 m0, s69, 3072
    s_mul_i32 s68, s93, 5120
    s_add_u32 s68, s68, 3072
    buffer_load_dwordx4 v9, s[24:27], s68 offen sc1 lds
    s_add_u32 m0, s69, 4096
    s_mul_i32 s68, s93, 5120
    s_add_u32 s68, s68, 4096
    buffer_load_dwordx4 v9, s[24:27], s68 offen sc1 lds
    s_add_u32 m0, s69, 5120
    s_mul_i32 s68, s94, 5120
    s_add_u32 s68, s68, 0
    buffer_load_dwordx4 v9, s[24:27], s68 offen sc1 lds
    s_add_u32 m0, s69, 6144
    s_mul_i32 s68, s94, 5120
    s_add_u32 s68, s68, 1024
    buffer_load_dwordx4 v9, s[24:27], s68 offen sc1 lds
    s_add_u32 m0, s69, 7168
    s_mul_i32 s68, s94, 5120
    s_add_u32 s68, s68, 2048
    buffer_load_dwordx4 v9, s[24:27], s68 offen sc1 lds
    s_add_u32 m0, s3, 0
    s_mul_i32 s68, s94, 5120
    s_add_u32 s68, s68, 3072
    buffer_load_dwordx4 v9, s[24:27], s68 offen sc1 lds
    s_add_u32 m0, s3, 1024
    s_mul_i32 s68, s94, 5120
    s_add_u32 s68, s68, 4096
    buffer_load_dwordx4 v9, s[24:27], s68 offen sc1 lds
    s_add_u32 m0, s3, 3072
    s_mul_i32 s68, s95, 5120
    s_add_u32 s68, s68, 1024
    buffer_load_dwordx4 v9, s[24:27], s68 offen sc1 lds
    s_add_u32 m0, s3, 4096
    s_mul_i32 s68, s95, 5120
    s_add_u32 s68, s68, 2048
    buffer_load_dwordx4 v9, s[24:27], s68 offen sc1 lds
    s_add_u32 m0, s3, 5120
    s_mul_i32 s68, s95, 5120
    s_add_u32 s68, s68, 3072
    buffer_load_dwordx4 v9, s[24:27], s68 offen sc1 lds
    s_add_u32 m0, s3, 6144
    s_mul_i32 s68, s95, 5120
    s_add_u32 s68, s68, 4096
    buffer_load_dwordx4 v9, s[24:27], s68 offen sc1 lds
    s_add_u32 m0, s3, 7168
    s_mul_i32 s68, s96, 5120
    s_add_u32 s68, s68, 0
    buffer_load_dwordx4 v9, s[24:27], s68 offen sc1 lds
    s_add_u32 m0, s3, 8192
    s_mul_i32 s68, s96, 5120
    s_add_u32 s68, s68, 1024
    buffer_load_dwordx4 v9, s[24:27], s68 offen sc1 lds
    s_add_u32 m0, s3, 9216
    s_mul_i32 s68, s96, 5120
    s_add_u32 s68, s68, 2048
    buffer_load_dwordx4 v9, s[24:27], s68 offen sc1 lds
    s_add_u32 m0, s3, 10240
    s_mul_i32 s68, s96, 5120
    s_add_u32 s68, s68, 3072
    buffer_load_dwordx4 v9, s[24:27], s68 offen sc1 lds
    s_add_u32 m0, s3, 11264
    s_mul_i32 s68, s96, 5120
    s_add_u32 s68, s68, 4096
    buffer_load_dwordx4 v9, s[24:27], s68 offen sc1 lds
    s_add_u32 m0, s3, 2048
    s_mul_i32 s68, s95, 5120
    s_add_u32 s68, s68, 0
    buffer_load_dwordx4 v9, s[24:27], s68 offen sc1 lds
    s_branch Lphase2
Lidle:
    s_mov_b32 s16, s60
    s_mov_b32 s17, s61
    s_mov_b32 s18, 9699328
    s_mov_b32 s19, 0x00020000
    s_add_u32 s28, s60, 11534336
    s_addc_u32 s29, s61, 0
    s_mov_b32 s30, 4587520
    s_mov_b32 s31, 0x00020000
    s_mov_b32 s32, s58
    s_mov_b32 s33, s59
    s_mov_b32 s34, 256
    s_mov_b32 s35, 0x00020000
    s_cmp_ge_u32 s46, s87
    s_cbranch_scc1 Ldu_61
    buffer_load_dword v255, v254, s[36:39], s46 offen
    s_add_u32 s46, s46, s86
    s_cmp_ge_u32 s46, s87
    s_cbranch_scc1 Ldu_61
    buffer_load_dword v255, v254, s[36:39], s46 offen
    s_add_u32 s46, s46, s86
    s_cmp_ge_u32 s46, s87
    s_cbranch_scc1 Ldu_61
    buffer_load_dword v255, v254, s[36:39], s46 offen
    s_add_u32 s46, s46, s86
    s_cmp_ge_u32 s46, s87
    s_cbranch_scc1 Ldu_61
    buffer_load_dword v255, v254, s[36:39], s46 offen
    s_add_u32 s46, s46, s86
    s_cmp_ge_u32 s46, s87
    s_cbranch_scc1 Ldu_61
    buffer_load_dword v255, v254, s[36:39], s46 offen
    s_add_u32 s46, s46, s86
    s_cmp_ge_u32 s46, s87
    s_cbranch_scc1 Ldu_61
    buffer_load_dword v255, v254, s[36:39], s46 offen
    s_add_u32 s46, s46, s86
Ldu_61:
    s_and_b32 s73, s2, 7
    s_lshl_b32 s50, s73, 2
    s_bfe_u32 s74, s2, 0x20003
    s_add_u32 s50, s50, s74
    s_lshr_b32 s51, s2, 5
    s_lshl_b32 s74, s74, 1
    s_mul_i32 s73, s51, 2
    s_lshr_b32 s73, s73, 1
    s_add_u32 s74, s74, s73
    s_cmp_lt_u32 s62, 2
    s_cselect_b32 s99, 10, 9
    s_cmp_ge_u32 s74, s99
    s_cselect_b32 s75, s99, 0
    s_sub_u32 s88, s74, s75
    s_add_u32 s89, s88, 1
    s_cmp_eq_u32 s89, s99
    s_cselect_b32 s89, 0, s89
    s_add_u32 s90, s89, 1
    s_cmp_eq_u32 s90, s99
    s_cselect_b32 s90, 0, s90
    s_add_u32 s91, s90, 1
    s_cmp_eq_u32 s91, s99
    s_cselect_b32 s91, 0, s91
    s_add_u32 s92, s91, 1
    s_cmp_eq_u32 s92, s99
    s_cselect_b32 s92, 0, s92
    s_add_u32 s93, s92, 1
    s_cmp_eq_u32 s93, s99
    s_cselect_b32 s93, 0, s93
    s_add_u32 s94, s93, 1
    s_cmp_eq_u32 s94, s99
    s_cselect_b32 s94, 0, s94
    s_add_u32 s95, s94, 1
    s_cmp_eq_u32 s95, s99
    s_cselect_b32 s95, 0, s95
    s_add_u32 s96, s95, 1
    s_cmp_eq_u32 s96, s99
    s_cselect_b32 s96, 0, s96
    s_add_u32 s97, s96, 1
    s_cmp_eq_u32 s97, s99
    s_cselect_b32 s97, 0, s97
    s_mul_i32 s76, s62, 9
    s_min_u32 s75, s62, 2
    s_add_u32 s76, s76, s75
    v_lshrrev_b32 v4, 1, v1
    s_sub_u32 s75, s99, 1
    v_min_u32 v4, s75, v4
    v_add_u32 v4, s76, v4
    s_mul_i32 s75, s51, 5
    s_lshr_b32 s75, s75, 2
    s_mul_i32 s75, s75, 74
    v_and_b32 v5, 1, v1
    v_mul_u32_u24 v5, 74, v5
    v_add3_u32 v4, v4, v5, s75
    v_mul_u32_u24 v4, 10923, v4
    v_lshrrev_b32 v4, 16, v4
    v_lshlrev_b32 v4, 7, v4
    v_add_u32 v11, 4198400, v4
    s_mul_i32 s75, s51, 74
    s_add_u32 s75, s75, s76
    s_mul_i32 s75, s75, 5120
    s_add_u32 s75, s75, 11534336
    s_add_u32 s24, s60, s75
    s_addc_u32 s25, s61, 0
    s_mul_i32 s26, s99, 5120
    s_mov_b32 s27, 0x00020000
    s_mul_i32 s75, s50, 74
    s_add_u32 s75, s75, s76
    s_lshl_b32 s75, s75, 12
    s_add_u32 s20, s60, s75
    s_addc_u32 s21, s61, 0
    s_lshl_b32 s22, s99, 12
    s_mov_b32 s23, 0x00020000
    s_cmp_ge_u32 s62, 2
    s_cbranch_scc1 Ly_62
    s_lshr_b32 s73, s50, 1
    s_lshl_b32 s73, s73, 7
    s_lshl_b32 s74, s62, 5
    s_add_u32 s73, s73, s74
    s_add_u32 s73, s73, 2048
    v_and_b32 v4, 3, v1
    v_lshl_add_u32 v0, v4, 3, s73
    s_branch Ly_63
Ly_62:
    s_lshl_b32 s73, s50, 6
    s_add_u32 s74, s73, 63
    s_mul_i32 s73, s73, 27595
    s_lshr_b32 s73, s73, 22
    s_mul_i32 s74, s74, 27595
    s_lshr_b32 s74, s74, 22
    s_sub_u32 s74, s74, s73
    s_lshl_b32 s74, s74, 7
    s_lshl_b32 s73, s73, 7
    s_sub_u32 s75, s62, 2
    s_mul_i32 s75, s75, 3
    s_lshr_b32 s75, s75, 1
    s_lshl_b32 s75, s75, 3
    s_add_u32 s73, s73, s75
    v_and_b32 v4, 1, v1
    v_lshlrev_b32 v4, 3, v4
    v_bfe_u32 v5, v1, 1, 1
    v_mul_u32_u24 v5, s74, v5
    v_add3_u32 v0, v4, v5, s73
Ly_63:
    v_lshlrev_b32 v0, 4, v0
    v_add_u32 v0, 4325376, v0
    s_lshl_b32 s73, s50, 6
    v_add_u32 v4, s73, v3
    v_mul_u32_u24 v4, 1280, v4
    v_lshl_add_u32 v4, v2, 3, v4
    s_mul_i32 s73, s51, 160
    v_add_u32 v10, s73, v4
    s_waitcnt vmcnt(0)
    s_cmp_lt_u32 s62, 2
    s_cbranch_scc1 Ltw_64
    v_lshrrev_b32 v4, 2, v1
    v_lshlrev_b32 v4, 7, v4
    v_and_b32 v5, 3, v1
    v_lshl_add_u32 v4, v5, 3, v4
    v_add_u32 v4, s42, v4
    ds_read_b64_tr_b16 v[232:233], v4 offset:0
    ds_read_b64_tr_b16 v[234:235], v4 offset:2048
    ds_read_b64_tr_b16 v[236:237], v4 offset:32
    ds_read_b64_tr_b16 v[238:239], v4 offset:2080
    ds_read_b64_tr_b16 v[240:241], v4 offset:64
    ds_read_b64_tr_b16 v[242:243], v4 offset:2112
    ds_read_b64_tr_b16 v[244:245], v4 offset:96
    ds_read_b64_tr_b16 v[246:247], v4 offset:2144
    s_waitcnt lgkmcnt(6)
    buffer_store_dwordx4 v[232:235], v9, s[28:31], s44 offen sc1
    s_waitcnt lgkmcnt(4)
    buffer_store_dwordx4 v[236:239], v9, s[28:31], s45 offen sc1
    s_waitcnt lgkmcnt(2)
    buffer_store_dwordx4 v[240:243], v9, s[28:31], s52 offen sc1
    s_waitcnt lgkmcnt(0)
    buffer_store_dwordx4 v[244:247], v9, s[28:31], s53 offen sc1
Ltw_64:
    v_mov_b32 v14, 0
    v_mov_b32 v15, 0
    s_waitcnt vmcnt(0)
    s_barrier
    s_mov_b32 s98, 0
Lno_65:
    v_readfirstlane_b32 s82, v14
    v_readfirstlane_b32 s83, v15
    s_add_u32 s98, s98, 1
    s_cmp_gt_u32 s98, 100000
    s_cbranch_scc1 Lno_66
    s_cmp_lg_u32 s82, 0
    s_cbranch_scc1 Lno_66
    v_mov_b32 v4, 0
    buffer_load_dwordx2 v[14:15], v4, s[32:35], 0 offen sc1
    s_waitcnt vmcnt(0)
    s_branch Lno_65
Lno_66:
    s_cmp_lg_u32 s62, 0
    s_cbranch_scc1 Lno_67
    s_lshl_b32 s74, s2, 7
    s_add_u32 s74, s74, 4182016
    v_lshlrev_b32 v4, 3, v1
    s_mov_b64 exec, 65535
    buffer_store_dwordx2 v[14:15], v4, s[28:31], s74 offen sc1
    s_mov_b64 exec, -1
Lno_67:
    s_mov_b32 s98, 0
Lpo_69:
    buffer_load_dwordx2 v[14:15], v11, s[28:31], 0 offen sc1
    s_waitcnt vmcnt(0)
Lpo_71:
    v_cmp_eq_u64 vcc, s[82:83], v[14:15]
    s_add_u32 s98, s98, 1
    s_cmp_gt_u32 s98, 100000
    s_cbranch_scc1 Lpo_70
    s_cmp_eq_u64 vcc, -1
    s_cbranch_scc0 Lpo_69
Lpo_70:
    s_lshl_b32 s69, s62, 13
    s_add_u32 s69, s69, 98304
    s_mul_i32 s3, s62, 12288
    s_mul_i32 s68, s91, 5120
    buffer_load_dwordx4 v[216:219], v9, s[24:27], s68 offen offset:0 sc1
    s_mul_i32 s68, s91, 5120
    buffer_load_dwordx4 v[220:223], v9, s[24:27], s68 offen offset:1024 sc1
    s_mul_i32 s68, s91, 5120
    buffer_load_dwordx4 v[224:227], v9, s[24:27], s68 offen offset:2048 sc1
    s_mul_i32 s68, s91, 5120
    buffer_load_dwordx4 v[228:231], v9, s[24:27], s68 offen offset:3072 sc1
    s_mul_i32 s68, s91, 5120
    s_add_u32 s68, s68, 4096
    buffer_load_dwordx4 v[232:235], v9, s[24:27], s68 offen sc1
    s_mul_i32 s68, s92, 5120
    buffer_load_dwordx4 v[236:239], v9, s[24:27], s68 offen offset:0 sc1
    s_mul_i32 s68, s92, 5120
    buffer_load_dwordx4 v[240:243], v9, s[24:27], s68 offen offset:1024 sc1
    s_mul_i32 s68, s92, 5120
    buffer_load_dwordx4 v[244:247], v9, s[24:27], s68 offen offset:2048 sc1
    s_mul_i32 s68, s92, 5120
    buffer_load_dwordx4 v[248:251], v9, s[24:27], s68 offen offset:3072 sc1
    s_mul_i32 s68, s92, 5120
    s_add_u32 s68, s68, 4096
    buffer_load_dwordx4 v[252:255], v9, s[24:27], s68 offen sc1
    s_mul_i32 s68, s88, 5120
    buffer_load_dwordx4 v[156:159], v9, s[24:27], s68 offen offset:0 sc1
    s_mul_i32 s68, s88, 5120
    buffer_load_dwordx4 v[160:163], v9, s[24:27], s68 offen offset:1024 sc1
    s_mul_i32 s68, s88, 5120
    buffer_load_dwordx4 v[164:167], v9, s[24:27], s68 offen offset:2048 sc1
    s_mul_i32 s68, s88, 5120
    buffer_load_dwordx4 v[168:171], v9, s[24:27], s68 offen offset:3072 sc1
    s_mul_i32 s68, s88, 5120
    s_add_u32 s68, s68, 4096
    buffer_load_dwordx4 v[172:175], v9, s[24:27], s68 offen sc1
    s_mul_i32 s68, s89, 5120
    buffer_load_dwordx4 v[176:179], v9, s[24:27], s68 offen offset:0 sc1
    s_mul_i32 s68, s89, 5120
    buffer_load_dwordx4 v[180:183], v9, s[24:27], s68 offen offset:1024 sc1
    s_mul_i32 s68, s89, 5120
    buffer_load_dwordx4 v[184:187], v9, s[24:27], s68 offen offset:2048 sc1
    s_mul_i32 s68, s89, 5120
    buffer_load_dwordx4 v[188:191], v9, s[24:27], s68 offen offset:3072 sc1
    s_mul_i32 s68, s89, 5120
    s_add_u32 s68, s68, 4096
    buffer_load_dwordx4 v[192:195], v9, s[24:27], s68 offen sc1
    s_mul_i32 s68, s90, 5120
    buffer_load_dwordx4 v[196:199], v9, s[24:27], s68 offen offset:0 sc1
    s_mul_i32 s68, s90, 5120
    buffer_load_dwordx4 v[200:203], v9, s[24:27], s68 offen offset:1024 sc1
    s_mul_i32 s68, s90, 5120
    buffer_load_dwordx4 v[204:207], v9, s[24:27], s68 offen offset:2048 sc1
    s_mul_i32 s68, s90, 5120
    buffer_load_dwordx4 v[208:211], v9, s[24:27], s68 offen offset:3072 sc1
    s_mul_i32 s68, s90, 5120
    s_add_u32 s68, s68, 4096
    buffer_load_dwordx4 v[212:215], v9, s[24:27], s68 offen sc1
    s_add_u32 m0, s69, 0
    s_mul_i32 s68, s93, 5120
    s_add_u32 s68, s68, 0
    buffer_load_dwordx4 v9, s[24:27], s68 offen sc1 lds
    s_add_u32 m0, s69, 1024
    s_mul_i32 s68, s93, 5120
    s_add_u32 s68, s68, 1024
    buffer_load_dwordx4 v9, s[24:27], s68 offen sc1 lds
    s_add_u32 m0, s69, 2048
    s_mul_i32 s68, s93, 5120
    s_add_u32 s68, s68, 2048
    buffer_load_dwordx4 v9, s[24:27], s68 offen sc1 lds
    s_add_u32 m0, s69, 3072
    s_mul_i32 s68, s93, 5120
    s_add_u32 s68, s68, 3072
    buffer_load_dwordx4 v9, s[24:27], s68 offen sc1 lds
    s_add_u32 m0, s69, 4096
    s_mul_i32 s68, s93, 5120
    s_add_u32 s68, s68, 4096
    buffer_load_dwordx4 v9, s[24:27], s68 offen sc1 lds
    s_add_u32 m0, s69, 5120
    s_mul_i32 s68, s94, 5120
    s_add_u32 s68, s68, 0
    buffer_load_dwordx4 v9, s[24:27], s68 offen sc1 lds
    s_add_u32 m0, s69, 6144
    s_mul_i32 s68, s94, 5120
    s_add_u32 s68, s68, 1024
    buffer_load_dwordx4 v9, s[24:27], s68 offen sc1 lds
    s_add_u32 m0, s69, 7168
    s_mul_i32 s68, s94, 5120
    s_add_u32 s68, s68, 2048
    buffer_load_dwordx4 v9, s[24:27], s68 offen sc1 lds
    s_add_u32 m0, s3, 0
    s_mul_i32 s68, s94, 5120
    s_add_u32 s68, s68, 3072
    buffer_load_dwordx4 v9, s[24:27], s68 offen sc1 lds
    s_add_u32 m0, s3, 1024
    s_mul_i32 s68, s94, 5120
    s_add_u32 s68, s68, 4096
    buffer_load_dwordx4 v9, s[24:27], s68 offen sc1 lds
    s_add_u32 m0, s3, 3072
    s_mul_i32 s68, s95, 5120
    s_add_u32 s68, s68, 1024
    buffer_load_dwordx4 v9, s[24:27], s68 offen sc1 lds
    s_add_u32 m0, s3, 4096
    s_mul_i32 s68, s95, 5120
    s_add_u32 s68, s68, 2048
    buffer_load_dwordx4 v9, s[24:27], s68 offen sc1 lds
    s_add_u32 m0, s3, 5120
    s_mul_i32 s68, s95, 5120
    s_add_u32 s68, s68, 3072
    buffer_load_dwordx4 v9, s[24:27], s68 offen sc1 lds
    s_add_u32 m0, s3, 6144
    s_mul_i32 s68, s95, 5120
    s_add_u32 s68, s68, 4096
    buffer_load_dwordx4 v9, s[24:27], s68 offen sc1 lds
    s_add_u32 m0, s3, 7168
    s_mul_i32 s68, s96, 5120
    s_add_u32 s68, s68, 0
    buffer_load_dwordx4 v9, s[24:27], s68 offen sc1 lds
    s_add_u32 m0, s3, 8192
    s_mul_i32 s68, s96, 5120
    s_add_u32 s68, s68, 1024
    buffer_load_dwordx4 v9, s[24:27], s68 offen sc1 lds
    s_add_u32 m0, s3, 9216
    s_mul_i32 s68, s96, 5120
    s_add_u32 s68, s68, 2048
    buffer_load_dwordx4 v9, s[24:27], s68 offen sc1 lds
    s_add_u32 m0, s3, 10240
    s_mul_i32 s68, s96, 5120
    s_add_u32 s68, s68, 3072
    buffer_load_dwordx4 v9, s[24:27], s68 offen sc1 lds
    s_add_u32 m0, s3, 11264
    s_mul_i32 s68, s96, 5120
    s_add_u32 s68, s68, 4096
    buffer_load_dwordx4 v9, s[24:27], s68 offen sc1 lds
    s_add_u32 m0, s3, 2048
    s_mul_i32 s68, s95, 5120
    s_add_u32 s68, s68, 0
    buffer_load_dwordx4 v9, s[24:27], s68 offen sc1 lds
    v_mov_b32 v12, 0
    v_mov_b32 v13, 0
Lphase2:
    v_mov_b32 v11, v9
    v_add_u32 v6, 1024, v9
    s_cmp_ge_u32 s62, 2
    s_cbranch_scc1 Lsv_72
    v_lshrrev_b32 v4, 3, v3
    v_lshlrev_b32 v4, 10, v4
    v_lshl_add_u32 v4, v2, 8, v4
    v_and_b32 v7, 7, v3
    v_lshl_add_u32 v11, v7, 4, v4
    v_add_u32 v6, 128, v11
Lsv_72:
    s_mov_b32 s98, 0
Lpo_73:
    buffer_load_dwordx2 v[12:13], v0, s[28:31], 0 offen sc1
    s_waitcnt vmcnt(0)
Lpo_75:
    v_cmp_eq_u64 vcc, s[82:83], v[12:13]
    s_add_u32 s98, s98, 1
    s_cmp_gt_u32 s98, 100000
    s_cbranch_scc1 Lpo_74
    s_cmp_eq_u64 vcc, -1
    s_cbranch_scc0 Lpo_73
Lpo_74:
    s_lshl_b32 s76, s88, 12
    buffer_load_dwordx4 v[96:99], v11, s[20:23], s76 offen offset:0 sc1
    buffer_load_dwordx4 v[100:103], v6, s[20:23], s76 offen offset:0 sc1
    buffer_load_dwordx4 v[104:107], v11, s[20:23], s76 offen offset:2048 sc1
    buffer_load_dwordx4 v[108:111], v6, s[20:23], s76 offen offset:2048 sc1
    s_lshl_b32 s76, s89, 12
    buffer_load_dwordx4 v[112:115], v11, s[20:23], s76 offen offset:0 sc1
    buffer_load_dwordx4 v[116:119], v6, s[20:23], s76 offen offset:0 sc1
    buffer_load_dwordx4 v[120:123], v11, s[20:23], s76 offen offset:2048 sc1
    buffer_load_dwordx4 v[124:127], v6, s[20:23], s76 offen offset:2048 sc1
    s_lshl_b32 s76, s90, 12
    buffer_load_dwordx4 v[136:139], v11, s[20:23], s76 offen offset:0 sc1
    buffer_load_dwordx4 v[140:143], v6, s[20:23], s76 offen offset:0 sc1
    buffer_load_dwordx4 v[144:147], v11, s[20:23], s76 offen offset:2048 sc1
    buffer_load_dwordx4 v[148:151], v6, s[20:23], s76 offen offset:2048 sc1
    s_waitcnt vmcnt(8)
    v_mfma_f32_16x16x32_bf16 v[16:19], v[156:159], v[96:99], 0
    v_add_u32 v14, s69, v9
    v_add_u32 v15, s3, v9
    s_mul_i32 s73, s51, 160
    v_mfma_f32_16x16x32_bf16 v[20:23], v[156:159], v[100:103], 0
    s_add_u32 s74, s62, 0
    s_mul_i32 s75, s74, 52
    s_lshr_b32 s75, s75, 8
    v_mfma_f32_16x16x32_bf16 v[24:27], v[156:159], v[104:107], 0
    s_mul_i32 s76, s75, 5
    s_sub_u32 s74, s74, s76
    s_lshl_b32 s74, s74, 5
    v_mfma_f32_16x16x32_bf16 v[28:31], v[156:159], v[108:111], 0
    v_mfma_f32_16x16x32_bf16 v[32:35], v[160:163], v[96:99], 0
    s_mul_i32 s75, s75, 20480
    s_add_u32 s66, s75, s74
    s_add_u32 s71, s73, s74
    v_mfma_f32_16x16x32_bf16 v[36:39], v[160:163], v[100:103], 0
    s_add_u32 s74, s62, 8
    s_mul_i32 s75, s74, 52
    s_lshr_b32 s75, s75, 8
    v_mfma_f32_16x16x32_bf16 v[40:43], v[160:163], v[104:107], 0
    s_mul_i32 s76, s75, 5
    s_sub_u32 s74, s74, s76
    s_lshl_b32 s74, s74, 5
    v_mfma_f32_16x16x32_bf16 v[44:47], v[160:163], v[108:111], 0
    v_mfma_f32_16x16x32_bf16 v[48:51], v[164:167], v[96:99], 0
    s_mul_i32 s75, s75, 20480
    s_add_u32 s67, s75, s74
    s_add_u32 s72, s73, s74
    v_mfma_f32_16x16x32_bf16 v[52:55], v[164:167], v[100:103], 0
    s_add_u32 s74, s62, 16
    s_mul_i32 s75, s74, 52
    s_lshr_b32 s75, s75, 8
    v_mfma_f32_16x16x32_bf16 v[56:59], v[164:167], v[104:107], 0
    s_mul_i32 s76, s75, 5
    s_sub_u32 s74, s74, s76
    s_lshl_b32 s74, s74, 5
    v_mfma_f32_16x16x32_bf16 v[60:63], v[164:167], v[108:111], 0
    v_mfma_f32_16x16x32_bf16 v[64:67], v[168:171], v[96:99], 0
    s_mul_i32 s75, s75, 20480
    s_add_u32 s70, s75, s74
    s_add_u32 s77, s73, s74
    v_mfma_f32_16x16x32_bf16 v[68:71], v[168:171], v[100:103], 0
    s_mov_b32 s36, s54
    s_mov_b32 s37, s55
    v_mfma_f32_16x16x32_bf16 v[72:75], v[168:171], v[104:107], 0
    s_mov_b32 s38, 1280
    s_mov_b32 s39, 0x00020000
    v_mfma_f32_16x16x32_bf16 v[76:79], v[168:171], v[108:111], 0
    v_mfma_f32_16x16x32_bf16 v[80:83], v[172:175], v[96:99], 0
    s_mov_b32 s8, s56
    s_mov_b32 s9, s57
    v_mfma_f32_16x16x32_bf16 v[84:87], v[172:175], v[100:103], 0
    s_mov_b32 s10, 2621440
    s_mov_b32 s11, 0x00020000
    v_mfma_f32_16x16x32_bf16 v[88:91], v[172:175], v[104:107], 0
    v_lshlrev_b32 v5, 3, v2
    v_mfma_f32_16x16x32_bf16 v[92:95], v[172:175], v[108:111], 0
    s_waitcnt vmcnt(4)
    v_mfma_f32_16x16x32_bf16 v[16:19], v[176:179], v[112:115], v[16:19]
    s_lshl_b32 s76, s91, 12
    buffer_load_dwordx4 v[96:99], v11, s[20:23], s76 offen offset:0 sc1
    v_mfma_f32_16x16x32_bf16 v[20:23], v[176:179], v[116:119], v[20:23]
    v_mfma_f32_16x16x32_bf16 v[24:27], v[176:179], v[120:123], v[24:27]
    ds_read_b128 v[156:159], v14 offset:0
    v_mfma_f32_16x16x32_bf16 v[28:31], v[176:179], v[124:127], v[28:31]
    v_mfma_f32_16x16x32_bf16 v[32:35], v[180:183], v[112:115], v[32:35]
    buffer_load_dwordx4 v[100:103], v6, s[20:23], s76 offen offset:0 sc1
    v_mfma_f32_16x16x32_bf16 v[36:39], v[180:183], v[116:119], v[36:39]
    v_mfma_f32_16x16x32_bf16 v[40:43], v[180:183], v[120:123], v[40:43]
    ds_read_b128 v[160:163], v14 offset:1024
    v_mfma_f32_16x16x32_bf16 v[44:47], v[180:183], v[124:127], v[44:47]
    v_mfma_f32_16x16x32_bf16 v[48:51], v[184:187], v[112:115], v[48:51]
    v_mfma_f32_16x16x32_bf16 v[52:55], v[184:187], v[116:119], v[52:55]
    buffer_load_dwordx4 v[104:107], v11, s[20:23], s76 offen offset:2048 sc1
    v_mfma_f32_16x16x32_bf16 v[56:59], v[184:187], v[120:123], v[56:59]
    ds_read_b128 v[164:167], v14 offset:2048
    v_mfma_f32_16x16x32_bf16 v[60:63], v[184:187], v[124:127], v[60:63]
    v_mfma_f32_16x16x32_bf16 v[64:67], v[188:191], v[112:115], v[64:67]
    v_mfma_f32_16x16x32_bf16 v[68:71], v[188:191], v[116:119], v[68:71]
    buffer_load_dwordx4 v[108:111], v6, s[20:23], s76 offen offset:2048 sc1
    v_mfma_f32_16x16x32_bf16 v[72:75], v[188:191], v[120:123], v[72:75]
    ds_read_b128 v[168:171], v14 offset:3072
    v_mfma_f32_16x16x32_bf16 v[76:79], v[188:191], v[124:127], v[76:79]
    v_mfma_f32_16x16x32_bf16 v[80:83], v[192:195], v[112:115], v[80:83]
    v_mfma_f32_16x16x32_bf16 v[84:87], v[192:195], v[116:119], v[84:87]
    v_mfma_f32_16x16x32_bf16 v[88:91], v[192:195], v[120:123], v[88:91]
    ds_read_b128 v[172:175], v14 offset:4096
    v_mfma_f32_16x16x32_bf16 v[92:95], v[192:195], v[124:127], v[92:95]
    s_waitcnt vmcnt(4)
    v_mfma_f32_16x16x32_bf16 v[16:19], v[196:199], v[136:139], v[16:19]
    s_lshl_b32 s76, s92, 12
    buffer_load_dwordx4 v[112:115], v11, s[20:23], s76 offen offset:0 sc1
    v_mfma_f32_16x16x32_bf16 v[20:23], v[196:199], v[140:143], v[20:23]
    v_mfma_f32_16x16x32_bf16 v[24:27], v[196:199], v[144:147], v[24:27]
    ds_read_b128 v[176:179], v14 offset:5120
    v_mfma_f32_16x16x32_bf16 v[28:31], v[196:199], v[148:151], v[28:31]
    v_mfma_f32_16x16x32_bf16 v[32:35], v[200:203], v[136:139], v[32:35]
    buffer_load_dwordx4 v[116:119], v6, s[20:23], s76 offen offset:0 sc1
    v_mfma_f32_16x16x32_bf16 v[36:39], v[200:203], v[140:143], v[36:39]
    v_mfma_f32_16x16x32_bf16 v[40:43], v[200:203], v[144:147], v[40:43]
    ds_read_b128 v[180:183], v14 offset:6144
    v_mfma_f32_16x16x32_bf16 v[44:47], v[200:203], v[148:151], v[44:47]
    v_mfma_f32_16x16x32_bf16 v[48:51], v[204:207], v[136:139], v[48:51]
    v_mfma_f32_16x16x32_bf16 v[52:55], v[204:207], v[140:143], v[52:55]
    buffer_load_dwordx4 v[120:123], v11, s[20:23], s76 offen offset:2048 sc1
    v_mfma_f32_16x16x32_bf16 v[56:59], v[204:207], v[144:147], v[56:59]
    ds_read_b128 v[184:187], v14 offset:7168
    v_mfma_f32_16x16x32_bf16 v[60:63], v[204:207], v[148:151], v[60:63]
    v_mfma_f32_16x16x32_bf16 v[64:67], v[208:211], v[136:139], v[64:67]
    v_mfma_f32_16x16x32_bf16 v[68:71], v[208:211], v[140:143], v[68:71]
    buffer_load_dwordx4 v[124:127], v6, s[20:23], s76 offen offset:2048 sc1
    v_mfma_f32_16x16x32_bf16 v[72:75], v[208:211], v[144:147], v[72:75]
    ds_read_b128 v[188:191], v15 offset:0
    v_mfma_f32_16x16x32_bf16 v[76:79], v[208:211], v[148:151], v[76:79]
    v_mfma_f32_16x16x32_bf16 v[80:83], v[212:215], v[136:139], v[80:83]
    v_mfma_f32_16x16x32_bf16 v[84:87], v[212:215], v[140:143], v[84:87]
    v_mfma_f32_16x16x32_bf16 v[88:91], v[212:215], v[144:147], v[88:91]
    ds_read_b128 v[192:195], v15 offset:1024
    v_mfma_f32_16x16x32_bf16 v[92:95], v[212:215], v[148:151], v[92:95]
    s_waitcnt vmcnt(4)
    v_mfma_f32_16x16x32_bf16 v[16:19], v[216:219], v[96:99], v[16:19]
    s_lshl_b32 s76, s93, 12
    buffer_load_dwordx4 v[136:139], v11, s[20:23], s76 offen offset:0 sc1
    v_mfma_f32_16x16x32_bf16 v[20:23], v[216:219], v[100:103], v[20:23]
    v_mfma_f32_16x16x32_bf16 v[24:27], v[216:219], v[104:107], v[24:27]
    ds_read_b128 v[196:199], v15 offset:2048
    v_mfma_f32_16x16x32_bf16 v[28:31], v[216:219], v[108:111], v[28:31]
    v_mfma_f32_16x16x32_bf16 v[32:35], v[220:223], v[96:99], v[32:35]
    buffer_load_dwordx4 v[140:143], v6, s[20:23], s76 offen offset:0 sc1
    v_mfma_f32_16x16x32_bf16 v[36:39], v[220:223], v[100:103], v[36:39]
    v_mfma_f32_16x16x32_bf16 v[40:43], v[220:223], v[104:107], v[40:43]
    ds_read_b128 v[200:203], v15 offset:3072
    v_mfma_f32_16x16x32_bf16 v[44:47], v[220:223], v[108:111], v[44:47]
    v_mfma_f32_16x16x32_bf16 v[48:51], v[224:227], v[96:99], v[48:51]
    v_mfma_f32_16x16x32_bf16 v[52:55], v[224:227], v[100:103], v[52:55]
    buffer_load_dwordx4 v[144:147], v11, s[20:23], s76 offen offset:2048 sc1
    v_mfma_f32_16x16x32_bf16 v[56:59], v[224:227], v[104:107], v[56:59]
    ds_read_b128 v[204:207], v15 offset:4096
    v_mfma_f32_16x16x32_bf16 v[60:63], v[224:227], v[108:111], v[60:63]
    v_mfma_f32_16x16x32_bf16 v[64:67], v[228:231], v[96:99], v[64:67]
    v_mfma_f32_16x16x32_bf16 v[68:71], v[228:231], v[100:103], v[68:71]
    buffer_load_dwordx4 v[148:151], v6, s[20:23], s76 offen offset:2048 sc1
    v_mfma_f32_16x16x32_bf16 v[72:75], v[228:231], v[104:107], v[72:75]
    ds_read_b128 v[208:211], v15 offset:5120
    v_mfma_f32_16x16x32_bf16 v[76:79], v[228:231], v[108:111], v[76:79]
    v_mfma_f32_16x16x32_bf16 v[80:83], v[232:235], v[96:99], v[80:83]
    v_mfma_f32_16x16x32_bf16 v[84:87], v[232:235], v[100:103], v[84:87]
    v_mfma_f32_16x16x32_bf16 v[88:91], v[232:235], v[104:107], v[88:91]
    ds_read_b128 v[212:215], v15 offset:6144
    v_mfma_f32_16x16x32_bf16 v[92:95], v[232:235], v[108:111], v[92:95]
    s_waitcnt vmcnt(4)
    v_mfma_f32_16x16x32_bf16 v[16:19], v[236:239], v[112:115], v[16:19]
    s_lshl_b32 s76, s94, 12
    buffer_load_dwordx4 v[96:99], v11, s[20:23], s76 offen offset:0 sc1
    v_mfma_f32_16x16x32_bf16 v[20:23], v[236:239], v[116:119], v[20:23]
    v_mfma_f32_16x16x32_bf16 v[24:27], v[236:239], v[120:123], v[24:27]
    ds_read_b128 v[216:219], v15 offset:7168
    v_mfma_f32_16x16x32_bf16 v[28:31], v[236:239], v[124:127], v[28:31]
    v_mfma_f32_16x16x32_bf16 v[32:35], v[240:243], v[112:115], v[32:35]
    buffer_load_dwordx4 v[100:103], v6, s[20:23], s76 offen offset:0 sc1
    v_mfma_f32_16x16x32_bf16 v[36:39], v[240:243], v[116:119], v[36:39]
    v_mfma_f32_16x16x32_bf16 v[40:43], v[240:243], v[120:123], v[40:43]
    ds_read_b128 v[220:223], v15 offset:8192
    v_mfma_f32_16x16x32_bf16 v[44:47], v[240:243], v[124:127], v[44:47]
    v_mfma_f32_16x16x32_bf16 v[48:51], v[244:247], v[112:115], v[48:51]
    v_mfma_f32_16x16x32_bf16 v[52:55], v[244:247], v[116:119], v[52:55]
    buffer_load_dwordx4 v[104:107], v11, s[20:23], s76 offen offset:2048 sc1
    v_mfma_f32_16x16x32_bf16 v[56:59], v[244:247], v[120:123], v[56:59]
    ds_read_b128 v[224:227], v15 offset:9216
    v_mfma_f32_16x16x32_bf16 v[60:63], v[244:247], v[124:127], v[60:63]
    v_mfma_f32_16x16x32_bf16 v[64:67], v[248:251], v[112:115], v[64:67]
    v_mfma_f32_16x16x32_bf16 v[68:71], v[248:251], v[116:119], v[68:71]
    buffer_load_dwordx4 v[108:111], v6, s[20:23], s76 offen offset:2048 sc1
    v_mfma_f32_16x16x32_bf16 v[72:75], v[248:251], v[120:123], v[72:75]
    ds_read_b128 v[228:231], v15 offset:10240
    v_mfma_f32_16x16x32_bf16 v[76:79], v[248:251], v[124:127], v[76:79]
    v_mfma_f32_16x16x32_bf16 v[80:83], v[252:255], v[112:115], v[80:83]
    v_mfma_f32_16x16x32_bf16 v[84:87], v[252:255], v[116:119], v[84:87]
    v_mfma_f32_16x16x32_bf16 v[88:91], v[252:255], v[120:123], v[88:91]
    ds_read_b128 v[232:235], v15 offset:11264
    v_mfma_f32_16x16x32_bf16 v[92:95], v[252:255], v[124:127], v[92:95]
    s_waitcnt vmcnt(4) lgkmcnt(0)
    v_mfma_f32_16x16x32_bf16 v[16:19], v[156:159], v[136:139], v[16:19]
    s_lshl_b32 s76, s95, 12
    buffer_load_dwordx4 v[112:115], v11, s[20:23], s76 offen offset:0 sc1
    v_mfma_f32_16x16x32_bf16 v[20:23], v[156:159], v[140:143], v[20:23]
    v_mfma_f32_16x16x32_bf16 v[24:27], v[156:159], v[144:147], v[24:27]
    v_mfma_f32_16x16x32_bf16 v[28:31], v[156:159], v[148:151], v[28:31]
    v_mfma_f32_16x16x32_bf16 v[32:35], v[160:163], v[136:139], v[32:35]
    buffer_load_dwordx4 v[116:119], v6, s[20:23], s76 offen offset:0 sc1
    v_mfma_f32_16x16x32_bf16 v[36:39], v[160:163], v[140:143], v[36:39]
    v_mfma_f32_16x16x32_bf16 v[40:43], v[160:163], v[144:147], v[40:43]
    v_mfma_f32_16x16x32_bf16 v[44:47], v[160:163], v[148:151], v[44:47]
    v_mfma_f32_16x16x32_bf16 v[48:51], v[164:167], v[136:139], v[48:51]
    v_mfma_f32_16x16x32_bf16 v[52:55], v[164:167], v[140:143], v[52:55]
    buffer_load_dwordx4 v[120:123], v11, s[20:23], s76 offen offset:2048 sc1
    v_mfma_f32_16x16x32_bf16 v[56:59], v[164:167], v[144:147], v[56:59]
    v_mfma_f32_16x16x32_bf16 v[60:63], v[164:167], v[148:151], v[60:63]
    v_mfma_f32_16x16x32_bf16 v[64:67], v[168:171], v[136:139], v[64:67]
    v_mfma_f32_16x16x32_bf16 v[68:71], v[168:171], v[140:143], v[68:71]
    buffer_load_dwordx4 v[124:127], v6, s[20:23], s76 offen offset:2048 sc1
    v_mfma_f32_16x16x32_bf16 v[72:75], v[168:171], v[144:147], v[72:75]
    v_mfma_f32_16x16x32_bf16 v[76:79], v[168:171], v[148:151], v[76:79]
    v_mfma_f32_16x16x32_bf16 v[80:83], v[172:175], v[136:139], v[80:83]
    v_mfma_f32_16x16x32_bf16 v[84:87], v[172:175], v[140:143], v[84:87]
    v_mfma_f32_16x16x32_bf16 v[88:91], v[172:175], v[144:147], v[88:91]
    s_cmp_ge_u32 s62, 2
    s_cbranch_scc1 Lso_76
    s_mul_i32 s68, s97, 5120
    buffer_load_dwordx4 v[236:239], v9, s[24:27], s68 offen offset:0 sc1
    s_mul_i32 s68, s97, 5120
    buffer_load_dwordx4 v[240:243], v9, s[24:27], s68 offen offset:1024 sc1
    s_mul_i32 s68, s97, 5120
    buffer_load_dwordx4 v[244:247], v9, s[24:27], s68 offen offset:2048 sc1
    s_mul_i32 s68, s97, 5120
    buffer_load_dwordx4 v[248:251], v9, s[24:27], s68 offen offset:3072 sc1
    s_mul_i32 s68, s97, 5120
    s_add_u32 s68, s68, 4096
    buffer_load_dwordx4 v[252:255], v9, s[24:27], s68 offen sc1
Lso_76:
    v_mfma_f32_16x16x32_bf16 v[92:95], v[172:175], v[148:151], v[92:95]
    s_waitcnt vmcnt(4)
    v_mfma_f32_16x16x32_bf16 v[16:19], v[176:179], v[96:99], v[16:19]
    s_lshl_b32 s76, s96, 12
    buffer_load_dwordx4 v[136:139], v11, s[20:23], s76 offen offset:0 sc1
    v_mfma_f32_16x16x32_bf16 v[20:23], v[176:179], v[100:103], v[20:23]
    v_mfma_f32_16x16x32_bf16 v[24:27], v[176:179], v[104:107], v[24:27]
    v_mfma_f32_16x16x32_bf16 v[28:31], v[176:179], v[108:111], v[28:31]
    v_mfma_f32_16x16x32_bf16 v[32:35], v[180:183], v[96:99], v[32:35]
    buffer_load_dwordx4 v[140:143], v6, s[20:23], s76 offen offset:0 sc1
    v_mfma_f32_16x16x32_bf16 v[36:39], v[180:183], v[100:103], v[36:39]
    v_mfma_f32_16x16x32_bf16 v[40:43], v[180:183], v[104:107], v[40:43]
    v_mfma_f32_16x16x32_bf16 v[44:47], v[180:183], v[108:111], v[44:47]
    v_mfma_f32_16x16x32_bf16 v[48:51], v[184:187], v[96:99], v[48:51]
    v_mfma_f32_16x16x32_bf16 v[52:55], v[184:187], v[100:103], v[52:55]
    buffer_load_dwordx4 v[144:147], v11, s[20:23], s76 offen offset:2048 sc1
    v_mfma_f32_16x16x32_bf16 v[56:59], v[184:187], v[104:107], v[56:59]
    v_mfma_f32_16x16x32_bf16 v[60:63], v[184:187], v[108:111], v[60:63]
    v_mfma_f32_16x16x32_bf16 v[64:67], v[188:191], v[96:99], v[64:67]
    v_mfma_f32_16x16x32_bf16 v[68:71], v[188:191], v[100:103], v[68:71]
    buffer_load_dwordx4 v[148:151], v6, s[20:23], s76 offen offset:2048 sc1
    v_mfma_f32_16x16x32_bf16 v[72:75], v[188:191], v[104:107], v[72:75]
    v_mfma_f32_16x16x32_bf16 v[76:79], v[188:191], v[108:111], v[76:79]
    v_mfma_f32_16x16x32_bf16 v[80:83], v[192:195], v[96:99], v[80:83]
    v_mfma_f32_16x16x32_bf16 v[84:87], v[192:195], v[100:103], v[84:87]
    v_mfma_f32_16x16x32_bf16 v[88:91], v[192:195], v[104:107], v[88:91]
    s_cmp_ge_u32 s62, 2
    s_cbranch_scc1 Lso_77
    s_lshl_b32 s76, s97, 12
    buffer_load_dwordx4 v[156:159], v11, s[20:23], s76 offen offset:0 sc1
    buffer_load_dwordx4 v[160:163], v6, s[20:23], s76 offen offset:0 sc1
    buffer_load_dwordx4 v[164:167], v11, s[20:23], s76 offen offset:2048 sc1
    buffer_load_dwordx4 v[168:171], v6, s[20:23], s76 offen offset:2048 sc1
Lso_77:
    v_mfma_f32_16x16x32_bf16 v[92:95], v[192:195], v[108:111], v[92:95]
    s_waitcnt vmcnt(4)
    v_mfma_f32_16x16x32_bf16 v[16:19], v[196:199], v[112:115], v[16:19]
    v_mfma_f32_16x16x32_bf16 v[20:23], v[196:199], v[116:119], v[20:23]
    buffer_load_dwordx2 v[128:129], v10, s[4:7], s66 offen
    v_mfma_f32_16x16x32_bf16 v[24:27], v[196:199], v[120:123], v[24:27]
    v_mfma_f32_16x16x32_bf16 v[28:31], v[196:199], v[124:127], v[28:31]
    v_mfma_f32_16x16x32_bf16 v[32:35], v[200:203], v[112:115], v[32:35]
    buffer_load_dwordx2 v[134:135], v5, s[36:39], s71 offen
    v_mfma_f32_16x16x32_bf16 v[36:39], v[200:203], v[116:119], v[36:39]
    v_mfma_f32_16x16x32_bf16 v[40:43], v[200:203], v[120:123], v[40:43]
    v_mfma_f32_16x16x32_bf16 v[44:47], v[200:203], v[124:127], v[44:47]
    buffer_load_dwordx2 v[130:131], v10, s[4:7], s67 offen
    v_mfma_f32_16x16x32_bf16 v[48:51], v[204:207], v[112:115], v[48:51]
    v_mfma_f32_16x16x32_bf16 v[52:55], v[204:207], v[116:119], v[52:55]
    v_mfma_f32_16x16x32_bf16 v[56:59], v[204:207], v[120:123], v[56:59]
    buffer_load_dwordx2 v[152:153], v5, s[36:39], s72 offen
    v_mfma_f32_16x16x32_bf16 v[60:63], v[204:207], v[124:127], v[60:63]
    v_mfma_f32_16x16x32_bf16 v[64:67], v[208:211], v[112:115], v[64:67]
    v_mfma_f32_16x16x32_bf16 v[68:71], v[208:211], v[116:119], v[68:71]
    buffer_load_dwordx2 v[132:133], v10, s[4:7], s70 offen
    v_mfma_f32_16x16x32_bf16 v[72:75], v[208:211], v[120:123], v[72:75]
    v_mfma_f32_16x16x32_bf16 v[76:79], v[208:211], v[124:127], v[76:79]
    v_mfma_f32_16x16x32_bf16 v[80:83], v[212:215], v[112:115], v[80:83]
    buffer_load_dwordx2 v[154:155], v5, s[36:39], s77 offen
    v_mfma_f32_16x16x32_bf16 v[84:87], v[212:215], v[116:119], v[84:87]
    v_mfma_f32_16x16x32_bf16 v[88:91], v[212:215], v[120:123], v[88:91]
    v_mfma_f32_16x16x32_bf16 v[92:95], v[212:215], v[124:127], v[92:95]
    s_cmp_ge_u32 s62, 2
    s_cbranch_scc1 Lp2skip
    s_waitcnt vmcnt(6)
    v_mfma_f32_16x16x32_bf16 v[16:19], v[236:239], v[156:159], v[16:19]
    v_mfma_f32_16x16x32_bf16 v[20:23], v[236:239], v[160:163], v[20:23]
    v_mfma_f32_16x16x32_bf16 v[24:27], v[236:239], v[164:167], v[24:27]
    v_mfma_f32_16x16x32_bf16 v[28:31], v[236:239], v[168:171], v[28:31]
    v_mfma_f32_16x16x32_bf16 v[32:35], v[240:243], v[156:159], v[32:35]
    v_mfma_f32_16x16x32_bf16 v[36:39], v[240:243], v[160:163], v[36:39]
    v_mfma_f32_16x16x32_bf16 v[40:43], v[240:243], v[164:167], v[40:43]
    v_mfma_f32_16x16x32_bf16 v[44:47], v[240:243], v[168:171], v[44:47]
    v_mfma_f32_16x16x32_bf16 v[48:51], v[244:247], v[156:159], v[48:51]
    v_mfma_f32_16x16x32_bf16 v[52:55], v[244:247], v[160:163], v[52:55]
    v_mfma_f32_16x16x32_bf16 v[56:59], v[244:247], v[164:167], v[56:59]
    v_mfma_f32_16x16x32_bf16 v[60:63], v[244:247], v[168:171], v[60:63]
    v_mfma_f32_16x16x32_bf16 v[64:67], v[248:251], v[156:159], v[64:67]
    v_mfma_f32_16x16x32_bf16 v[68:71], v[248:251], v[160:163], v[68:71]
    v_mfma_f32_16x16x32_bf16 v[72:75], v[248:251], v[164:167], v[72:75]
    v_mfma_f32_16x16x32_bf16 v[76:79], v[248:251], v[168:171], v[76:79]
    v_mfma_f32_16x16x32_bf16 v[80:83], v[252:255], v[156:159], v[80:83]
    v_mfma_f32_16x16x32_bf16 v[84:87], v[252:255], v[160:163], v[84:87]
    v_mfma_f32_16x16x32_bf16 v[88:91], v[252:255], v[164:167], v[88:91]
    v_mfma_f32_16x16x32_bf16 v[92:95], v[252:255], v[168:171], v[92:95]
Lp2skip:
    s_waitcnt vmcnt(6)
    v_mfma_f32_16x16x32_bf16 v[16:19], v[216:219], v[136:139], v[16:19]
    v_mfma_f32_16x16x32_bf16 v[20:23], v[216:219], v[140:143], v[20:23]
    v_mfma_f32_16x16x32_bf16 v[24:27], v[216:219], v[144:147], v[24:27]
    v_mfma_f32_16x16x32_bf16 v[28:31], v[216:219], v[148:151], v[28:31]
    v_mfma_f32_16x16x32_bf16 v[32:35], v[220:223], v[136:139], v[32:35]
    v_mfma_f32_16x16x32_bf16 v[36:39], v[220:223], v[140:143], v[36:39]
    v_mfma_f32_16x16x32_bf16 v[40:43], v[220:223], v[144:147], v[40:43]
    v_mfma_f32_16x16x32_bf16 v[44:47], v[220:223], v[148:151], v[44:47]
    v_mfma_f32_16x16x32_bf16 v[48:51], v[224:227], v[136:139], v[48:51]
    ds_write_b128 v14, v[16:19] offset:0
    v_mfma_f32_16x16x32_bf16 v[52:55], v[224:227], v[140:143], v[52:55]
    ds_write_b128 v14, v[20:23] offset:5120
    v_mfma_f32_16x16x32_bf16 v[56:59], v[224:227], v[144:147], v[56:59]
    ds_write_b128 v15, v[24:27] offset:2048
    v_mfma_f32_16x16x32_bf16 v[60:63], v[224:227], v[148:151], v[60:63]
    ds_write_b128 v15, v[28:31] offset:7168
    v_mfma_f32_16x16x32_bf16 v[64:67], v[228:231], v[136:139], v[64:67]
    ds_write_b128 v14, v[32:35] offset:1024
    v_mfma_f32_16x16x32_bf16 v[68:71], v[228:231], v[140:143], v[68:71]
    ds_write_b128 v14, v[36:39] offset:6144
    v_mfma_f32_16x16x32_bf16 v[72:75], v[228:231], v[144:147], v[72:75]
    ds_write_b128 v15, v[40:43] offset:3072
    v_mfma_f32_16x16x32_bf16 v[76:79], v[228:231], v[148:151], v[76:79]
    ds_write_b128 v15, v[44:47] offset:8192
    v_mfma_f32_16x16x32_bf16 v[80:83], v[232:235], v[136:139], v[80:83]
    ds_write_b128 v14, v[48:51] offset:2048
    v_mfma_f32_16x16x32_bf16 v[84:87], v[232:235], v[140:143], v[84:87]
    ds_write_b128 v14, v[52:55] offset:7168
    v_mfma_f32_16x16x32_bf16 v[88:91], v[232:235], v[144:147], v[88:91]
    ds_write_b128 v15, v[56:59] offset:4096
    v_mfma_f32_16x16x32_bf16 v[92:95], v[232:235], v[148:151], v[92:95]
    ds_write_b128 v15, v[60:63] offset:9216
    s_nop 0
    ds_write_b128 v14, v[64:67] offset:3072
    ds_write_b128 v15, v[68:71] offset:0
    ds_write_b128 v15, v[72:75] offset:5120
    ds_write_b128 v15, v[76:79] offset:10240
    ds_write_b128 v14, v[80:83] offset:4096
    ds_write_b128 v15, v[84:87] offset:1024
    ds_write_b128 v15, v[88:91] offset:6144
    ds_write_b128 v15, v[92:95] offset:11264
    s_lshl_b32 s73, s62, 10
    v_add_u32 v4, s73, v9
    v_add_u32 v6, 98304, v4
    v_add_u32 v7, 49152, v4
    v_and_b32 v12, 1, v3
    v_lshrrev_b32 v13, 1, v3
    v_lshl_add_u32 v12, v12, 3, v13
    v_lshlrev_b32 v12, 4, v12
    v_lshl_add_u32 v12, v2, 8, v12
    v_add_u32 v12, s73, v12
    v_add_u32 v13, 98304, v12
    s_waitcnt lgkmcnt(0)
    s_barrier
    ds_read_b128 v[16:19], v13 offset:0
    ds_read_b128 v[20:23], v13 offset:8192
    ds_read_b128 v[24:27], v6 offset:16384
    ds_read_b128 v[28:31], v6 offset:24576
    ds_read_b128 v[32:35], v6 offset:32768
    ds_read_b128 v[36:39], v6 offset:40960
    ds_read_b128 v[40:43], v6 offset:49152
    ds_read_b128 v[44:47], v6 offset:57344
    ds_read_b128 v[48:51], v12 offset:0
    ds_read_b128 v[52:55], v12 offset:12288
    ds_read_b128 v[56:59], v4 offset:24576
    ds_read_b128 v[60:63], v4 offset:36864
    ds_read_b128 v[64:67], v7 offset:0
    ds_read_b128 v[68:71], v7 offset:12288
    ds_read_b128 v[72:75], v7 offset:24576
    ds_read_b128 v[76:79], v7 offset:36864
    s_cmp_ge_u32 s62, 4
    s_cbranch_scc1 L3_78
    ds_read_b128 v[80:83], v12 offset:8192
    ds_read_b128 v[84:87], v12 offset:20480
    ds_read_b128 v[88:91], v4 offset:32768
    ds_read_b128 v[92:95], v4 offset:45056
    ds_read_b128 v[96:99], v7 offset:8192
    ds_read_b128 v[100:103], v7 offset:20480
    ds_read_b128 v[104:107], v7 offset:32768
    ds_read_b128 v[108:111], v7 offset:45056
    s_waitcnt vmcnt(0) lgkmcnt(8)
    v_pk_add_f32 v[16:17], v[16:17], v[20:21]
    v_pk_add_f32 v[48:49], v[48:49], v[52:53]
    v_pk_add_f32 v[24:25], v[24:25], v[28:29]
    v_pk_add_f32 v[56:57], v[56:57], v[60:61]
    v_pk_add_f32 v[32:33], v[32:33], v[36:37]
    v_pk_add_f32 v[64:65], v[64:65], v[68:69]
    v_pk_add_f32 v[40:41], v[40:41], v[44:45]
    v_pk_add_f32 v[72:73], v[72:73], v[76:77]
    v_pk_add_f32 v[18:19], v[18:19], v[22:23]
    v_pk_add_f32 v[50:51], v[50:51], v[54:55]
    v_pk_add_f32 v[26:27], v[26:27], v[30:31]
    v_pk_add_f32 v[58:59], v[58:59], v[62:63]
    v_pk_add_f32 v[34:35], v[34:35], v[38:39]
    v_pk_add_f32 v[66:67], v[66:67], v[70:71]
    v_pk_add_f32 v[42:43], v[42:43], v[46:47]
    v_pk_add_f32 v[74:75], v[74:75], v[78:79]
    v_lshlrev_b32 v28, 16, v134
    v_lshlrev_b32 v60, 16, v152
    v_and_b32 v29, 0xffff0000, v134
    v_and_b32 v61, 0xffff0000, v152
    v_lshlrev_b32 v30, 16, v135
    v_lshlrev_b32 v62, 16, v153
    v_and_b32 v31, 0xffff0000, v135
    v_and_b32 v63, 0xffff0000, v153
    v_pk_add_f32 v[24:25], v[24:25], v[32:33]
    v_pk_add_f32 v[56:57], v[56:57], v[64:65]
    v_pk_add_f32 v[40:41], v[40:41], v[28:29]
    v_pk_add_f32 v[72:73], v[72:73], v[60:61]
    v_pk_add_f32 v[26:27], v[26:27], v[34:35]
    v_pk_add_f32 v[58:59], v[58:59], v[66:67]
    v_pk_add_f32 v[42:43], v[42:43], v[30:31]
    v_pk_add_f32 v[74:75], v[74:75], v[62:63]
    v_pk_add_f32 v[24:25], v[24:25], v[40:41]
    v_pk_add_f32 v[56:57], v[56:57], v[72:73]
    v_pk_add_f32 v[26:27], v[26:27], v[42:43]
    v_pk_add_f32 v[58:59], v[58:59], v[74:75]
    v_mul_f32 v28, 0xbfb8aa3b, v24
    v_mul_f32 v60, 0xbfb8aa3b, v56
    v_mul_f32 v29, 0xbfb8aa3b, v25
    v_mul_f32 v61, 0xbfb8aa3b, v57
    v_mul_f32 v30, 0xbfb8aa3b, v26
    v_mul_f32 v62, 0xbfb8aa3b, v58
    v_mul_f32 v31, 0xbfb8aa3b, v27
    v_mul_f32 v63, 0xbfb8aa3b, v59
    v_exp_f32 v28, v28
    v_exp_f32 v60, v60
    v_exp_f32 v29, v29
    v_exp_f32 v61, v61
    v_exp_f32 v30, v30
    v_exp_f32 v62, v62
    v_exp_f32 v31, v31
    v_exp_f32 v63, v63
    v_add_f32 v28, 1.0, v28
    v_add_f32 v60, 1.0, v60
    v_add_f32 v29, 1.0, v29
    v_add_f32 v61, 1.0, v61
    v_add_f32 v30, 1.0, v30
    v_add_f32 v62, 1.0, v62
    v_add_f32 v31, 1.0, v31
    v_add_f32 v63, 1.0, v63
    v_rcp_f32 v28, v28
    v_rcp_f32 v60, v60
    v_rcp_f32 v29, v29
    v_rcp_f32 v61, v61
    v_rcp_f32 v30, v30
    v_rcp_f32 v62, v62
    v_rcp_f32 v31, v31
    v_rcp_f32 v63, v63
    v_pk_mul_f32 v[24:25], v[24:25], v[16:17]
    v_pk_mul_f32 v[56:57], v[56:57], v[48:49]
    v_pk_mul_f32 v[26:27], v[26:27], v[18:19]
    v_pk_mul_f32 v[58:59], v[58:59], v[50:51]
    v_lshlrev_b32 v32, 16, v128
    v_lshlrev_b32 v64, 16, v130
    v_and_b32 v33, 0xffff0000, v128
    v_and_b32 v65, 0xffff0000, v130
    v_lshlrev_b32 v34, 16, v129
    v_lshlrev_b32 v66, 16, v131
    v_and_b32 v35, 0xffff0000, v129
    v_and_b32 v67, 0xffff0000, v131
    v_fma_f32 v24, v24, v28, v32
    v_fma_f32 v56, v56, v60, v64
    v_fma_f32 v25, v25, v29, v33
    v_fma_f32 v57, v57, v61, v65
    v_fma_f32 v26, v26, v30, v34
    v_fma_f32 v58, v58, v62, v66
    v_fma_f32 v27, v27, v31, v35
    v_fma_f32 v59, v59, v63, v67
    v_cvt_pk_bf16_f32 v16, v24, v25
    v_cvt_pk_bf16_f32 v48, v56, v57
    v_cvt_pk_bf16_f32 v17, v26, v27
    v_cvt_pk_bf16_f32 v49, v58, v59
    buffer_store_dwordx2 v[16:17], v10, s[8:11], s66 offen
    buffer_store_dwordx2 v[48:49], v10, s[8:11], s67 offen
    s_waitcnt lgkmcnt(0)
    v_pk_add_f32 v[80:81], v[80:81], v[84:85]
    v_pk_add_f32 v[88:89], v[88:89], v[92:93]
    v_pk_add_f32 v[96:97], v[96:97], v[100:101]
    v_pk_add_f32 v[104:105], v[104:105], v[108:109]
    v_pk_add_f32 v[82:83], v[82:83], v[86:87]
    v_pk_add_f32 v[90:91], v[90:91], v[94:95]
    v_pk_add_f32 v[98:99], v[98:99], v[102:103]
    v_pk_add_f32 v[106:107], v[106:107], v[110:111]
    v_lshlrev_b32 v92, 16, v154
    v_and_b32 v93, 0xffff0000, v154
    v_lshlrev_b32 v94, 16, v155
    v_and_b32 v95, 0xffff0000, v155
    v_pk_add_f32 v[88:89], v[88:89], v[96:97]
    v_pk_add_f32 v[104:105], v[104:105], v[92:93]
    v_pk_add_f32 v[90:91], v[90:91], v[98:99]
    v_pk_add_f32 v[106:107], v[106:107], v[94:95]
    v_pk_add_f32 v[88:89], v[88:89], v[104:105]
    v_pk_add_f32 v[90:91], v[90:91], v[106:107]
    v_mul_f32 v92, 0xbfb8aa3b, v88
    v_mul_f32 v93, 0xbfb8aa3b, v89
    v_mul_f32 v94, 0xbfb8aa3b, v90
    v_mul_f32 v95, 0xbfb8aa3b, v91
    v_exp_f32 v92, v92
    v_exp_f32 v93, v93
    v_exp_f32 v94, v94
    v_exp_f32 v95, v95
    v_add_f32 v92, 1.0, v92
    v_add_f32 v93, 1.0, v93
    v_add_f32 v94, 1.0, v94
    v_add_f32 v95, 1.0, v95
    v_rcp_f32 v92, v92
    v_rcp_f32 v93, v93
    v_rcp_f32 v94, v94
    v_rcp_f32 v95, v95
    v_pk_mul_f32 v[88:89], v[88:89], v[80:81]
    v_pk_mul_f32 v[90:91], v[90:91], v[82:83]
    v_lshlrev_b32 v96, 16, v132
    v_and_b32 v97, 0xffff0000, v132
    v_lshlrev_b32 v98, 16, v133
    v_and_b32 v99, 0xffff0000, v133
    v_fma_f32 v88, v88, v92, v96
    v_fma_f32 v89, v89, v93, v97
    v_fma_f32 v90, v90, v94, v98
    v_fma_f32 v91, v91, v95, v99
    v_cvt_pk_bf16_f32 v80, v88, v89
    v_cvt_pk_bf16_f32 v81, v90, v91
    buffer_store_dwordx2 v[80:81], v10, s[8:11], s70 offen
    s_branch Lfin
L3_78:
    s_waitcnt vmcnt(0) lgkmcnt(0)
    v_pk_add_f32 v[16:17], v[16:17], v[20:21]
    v_pk_add_f32 v[48:49], v[48:49], v[52:53]
    v_pk_add_f32 v[24:25], v[24:25], v[28:29]
    v_pk_add_f32 v[56:57], v[56:57], v[60:61]
    v_pk_add_f32 v[32:33], v[32:33], v[36:37]
    v_pk_add_f32 v[64:65], v[64:65], v[68:69]
    v_pk_add_f32 v[40:41], v[40:41], v[44:45]
    v_pk_add_f32 v[72:73], v[72:73], v[76:77]
    v_pk_add_f32 v[18:19], v[18:19], v[22:23]
    v_pk_add_f32 v[50:51], v[50:51], v[54:55]
    v_pk_add_f32 v[26:27], v[26:27], v[30:31]
    v_pk_add_f32 v[58:59], v[58:59], v[62:63]
    v_pk_add_f32 v[34:35], v[34:35], v[38:39]
    v_pk_add_f32 v[66:67], v[66:67], v[70:71]
    v_pk_add_f32 v[42:43], v[42:43], v[46:47]
    v_pk_add_f32 v[74:75], v[74:75], v[78:79]
    v_lshlrev_b32 v28, 16, v134
    v_lshlrev_b32 v60, 16, v152
    v_and_b32 v29, 0xffff0000, v134
    v_and_b32 v61, 0xffff0000, v152
    v_lshlrev_b32 v30, 16, v135
    v_lshlrev_b32 v62, 16, v153
    v_and_b32 v31, 0xffff0000, v135
    v_and_b32 v63, 0xffff0000, v153
    v_pk_add_f32 v[24:25], v[24:25], v[32:33]
    v_pk_add_f32 v[56:57], v[56:57], v[64:65]
    v_pk_add_f32 v[40:41], v[40:41], v[28:29]
    v_pk_add_f32 v[72:73], v[72:73], v[60:61]
    v_pk_add_f32 v[26:27], v[26:27], v[34:35]
    v_pk_add_f32 v[58:59], v[58:59], v[66:67]
    v_pk_add_f32 v[42:43], v[42:43], v[30:31]
    v_pk_add_f32 v[74:75], v[74:75], v[62:63]
    v_pk_add_f32 v[24:25], v[24:25], v[40:41]
    v_pk_add_f32 v[56:57], v[56:57], v[72:73]
    v_pk_add_f32 v[26:27], v[26:27], v[42:43]
    v_pk_add_f32 v[58:59], v[58:59], v[74:75]
    v_mul_f32 v28, 0xbfb8aa3b, v24
    v_mul_f32 v60, 0xbfb8aa3b, v56
    v_mul_f32 v29, 0xbfb8aa3b, v25
    v_mul_f32 v61, 0xbfb8aa3b, v57
    v_mul_f32 v30, 0xbfb8aa3b, v26
    v_mul_f32 v62, 0xbfb8aa3b, v58
    v_mul_f32 v31, 0xbfb8aa3b, v27
    v_mul_f32 v63, 0xbfb8aa3b, v59
    v_exp_f32 v28, v28
    v_exp_f32 v60, v60
    v_exp_f32 v29, v29
    v_exp_f32 v61, v61
    v_exp_f32 v30, v30
    v_exp_f32 v62, v62
    v_exp_f32 v31, v31
    v_exp_f32 v63, v63
    v_add_f32 v28, 1.0, v28
    v_add_f32 v60, 1.0, v60
    v_add_f32 v29, 1.0, v29
    v_add_f32 v61, 1.0, v61
    v_add_f32 v30, 1.0, v30
    v_add_f32 v62, 1.0, v62
    v_add_f32 v31, 1.0, v31
    v_add_f32 v63, 1.0, v63
    v_rcp_f32 v28, v28
    v_rcp_f32 v60, v60
    v_rcp_f32 v29, v29
    v_rcp_f32 v61, v61
    v_rcp_f32 v30, v30
    v_rcp_f32 v62, v62
    v_rcp_f32 v31, v31
    v_rcp_f32 v63, v63
    v_pk_mul_f32 v[24:25], v[24:25], v[16:17]
    v_pk_mul_f32 v[56:57], v[56:57], v[48:49]
    v_pk_mul_f32 v[26:27], v[26:27], v[18:19]
    v_pk_mul_f32 v[58:59], v[58:59], v[50:51]
    v_lshlrev_b32 v32, 16, v128
    v_lshlrev_b32 v64, 16, v130
    v_and_b32 v33, 0xffff0000, v128
    v_and_b32 v65, 0xffff0000, v130
    v_lshlrev_b32 v34, 16, v129
    v_lshlrev_b32 v66, 16, v131
    v_and_b32 v35, 0xffff0000, v129
    v_and_b32 v67, 0xffff0000, v131
    v_fma_f32 v24, v24, v28, v32
    v_fma_f32 v56, v56, v60, v64
    v_fma_f32 v25, v25, v29, v33
    v_fma_f32 v57, v57, v61, v65
    v_fma_f32 v26, v26, v30, v34
    v_fma_f32 v58, v58, v62, v66
    v_fma_f32 v27, v27, v31, v35
    v_fma_f32 v59, v59, v63, v67
    v_cvt_pk_bf16_f32 v16, v24, v25
    v_cvt_pk_bf16_f32 v48, v56, v57
    v_cvt_pk_bf16_f32 v17, v26, v27
    v_cvt_pk_bf16_f32 v49, v58, v59
    buffer_store_dwordx2 v[16:17], v10, s[8:11], s66 offen
    buffer_store_dwordx2 v[48:49], v10, s[8:11], s67 offen
Lfin:
Lend:
    s_endpgm
.section .rodata,"a"
.p2align 6
.amdhsa_kernel recurrent_scan__sliding_local_dilated__dense_activation_gelu__prompt_kernel
  .amdhsa_next_free_vgpr 256
  .amdhsa_next_free_sgpr 102
  .amdhsa_accum_offset 256
  .amdhsa_group_segment_fixed_size 0
  .amdhsa_kernarg_size 88
  .amdhsa_user_sgpr_count 2
  .amdhsa_user_sgpr_kernarg_segment_ptr 1
  .amdhsa_system_sgpr_workgroup_id_x 1
.end_amdhsa_kernel
```
